```python
import torch

def _softmax(x, axis=-1):
    return torch.softmax(x, dim=axis)
def _gelu(x):
    return torch.nn.functional.gelu(x, approximate="tanh")
def _silu(x):
    return torch.nn.functional.silu(x)
def _sigmoid(x):
    return torch.sigmoid(x)
def _layernorm(x, axis=-1, eps=1e-5):
    m = x.mean(dim=axis, keepdim=True)
    v = x.var(dim=axis, keepdim=True, unbiased=False)
    return (x - m) / torch.sqrt(v + eps)
def _scatter_add(tgt, idx, src, axis=0):
    return tgt.clone().index_add_(axis, idx, src)
def _segment_sum(src, seg, n):
    out = torch.zeros((n,) + src.shape[1:], dtype=src.dtype)
    return out.index_add_(0, seg, src)
def _pad(x, pw):
    flat = tuple(v for pair in reversed(pw) for v in pair)
    return torch.nn.functional.pad(x, flat)

kernel_name = 'sequential_preLN__spectral_gfnet__mixer_channel_mlp__prompt'

def setup_inputs():

    _w = (lambda a: (lambda t: t.to(torch.bfloat16) if t.is_floating_point() else t)(torch.as_tensor(a)))
    def _A_setup():
        B, S, D = 1, 2048, 512
        Df = D // 2 + 1
        return {
            "x": _w((lambda *s: torch.randn(*s, dtype=torch.bfloat16) * 0.05)(B, S, D)),
            "w_r": _w((lambda *s: torch.randn(*s, dtype=torch.bfloat16) * 0.8)(S, Df) * 0.02),
            "w_i": _w((lambda *s: torch.randn(*s, dtype=torch.bfloat16) * 0.8)(S, Df) * 0.02),
        }
    _A_in = _A_setup()

    def _B_setup():
        B, S, D, F = 1, 2048, 512, 1792
        return {
            "x": _w((lambda *s: torch.randn(*s, dtype=torch.bfloat16) * 0.05)(B, S, D)),
            "w1": _w((lambda *s: torch.randn(*s, dtype=torch.bfloat16) * 0.8)(D, F) * (D ** -0.5)),
            "b1": _w((lambda *s: torch.randn(*s, dtype=torch.bfloat16) * 0.4)(F)),
            "w2": _w((lambda *s: torch.randn(*s, dtype=torch.bfloat16) * 0.05)(F, D) * (F ** -0.5)),
            "b2": _w((lambda *s: torch.randn(*s, dtype=torch.bfloat16) * 0.05)(D)),
        }
    _B_in = _B_setup()

    return {
        "A_x": _A_in["x"],
        "A_w_r": _A_in["w_r"],
        "A_w_i": _A_in["w_i"],
        "B_x": _B_in["x"],
        "B_w1": _B_in["w1"],
        "B_b1": _B_in["b1"],
        "B_w2": _B_in["w2"],
        "B_b2": _B_in["b2"],
    }

def reference(A_x, A_w_r, A_w_i, B_x, B_w1, B_b1, B_w2, B_b2):
    def _A_ref(x, w_r, w_i):
        B, S, D = x.shape
        X = (lambda x, axes=(-2,-1): torch.fft.rfft2(x.float(), dim=axes))(x, axes=(-2, -1))
        W = w_r + 1j * w_i
        X = X * W
        y = (lambda x, s, axes=(-2,-1): torch.fft.irfft2(x, s=s, dim=axes).to(torch.bfloat16))(X, (S, D), axes=(-2, -1))
        return y

    def _B_ref(x, w1, b1, w2, b2):
        y = _layernorm(x, axis=-1)
        h = _gelu(torch.einsum("bsd,df->bsf", y, w1) + b1)
        return torch.einsum("bsf,fd->bsd", h, w2) + b2

    x = A_x
    h = x + _A_ref(_layernorm(x, axis=-1), A_w_r, A_w_i)
    h2 = h + _B_ref(_layernorm(h, axis=-1), B_w1, B_b1, B_w2, B_b2)
    return h2
```

```asm
; @launch grid=(256,1,1) block=(256,1,1) lds=163840
.amdgcn_target "amdgcn-amd-amdhsa--gfx950"
.text
.globl sequential_preLN__spectral_gfnet__mixer_channel_mlp__prompt_kernel
.p2align 8
.type sequential_preLN__spectral_gfnet__mixer_channel_mlp__prompt_kernel,@function
sequential_preLN__spectral_gfnet__mixer_channel_mlp__prompt_kernel:
    s_cmp_ge_u32 s2, 256
    s_cbranch_scc1 L_end
    s_load_dwordx2 s[4:5], s[0:1], 0
    s_load_dwordx2 s[8:9], s[0:1], 80
    s_load_dwordx2 s[24:25], s[0:1], 8
    s_load_dwordx2 s[28:29], s[0:1], 16
    s_load_dwordx2 s[12:13], s[0:1], 32
    s_load_dwordx2 s[16:17], s[0:1], 48
    s_load_dwordx2 s[32:33], s[0:1], 40
    s_load_dwordx2 s[36:37], s[0:1], 56
    s_load_dwordx2 s[20:21], s[0:1], 64
    v_lshrrev_b32 v12, 6, v0
    v_and_b32 v1, 63, v0
    v_readfirstlane_b32 s67, v12
    s_getpc_b64 s[40:41]
L_pc:
    s_mov_b32 s42, L_code_end-L_pc
    s_mov_b32 s43, 0x00020000
    v_lshlrev_b32 v13, 7, v0
    buffer_load_dword a230, v13, s[40:43], 0 offen
    s_mov_b32 s6, 0x200000
    s_mov_b32 s7, 0x00020000
    s_mov_b32 s10, 0x1900000
    s_mov_b32 s11, 0x00020000
    s_mov_b32 s26, 0x101000
    s_mov_b32 s27, 0x00020000
    s_mov_b32 s30, 0x101000
    s_mov_b32 s31, 0x00020000
    s_mov_b32 s14, 0x1c0000
    s_mov_b32 s15, 0x00020000
    s_mov_b32 s18, 0x1c0000
    s_mov_b32 s19, 0x00020000
    s_mov_b32 s34, 0xe00
    s_mov_b32 s35, 0x00020000
    s_mov_b32 s38, 0x400
    s_mov_b32 s39, 0x00020000
    s_mov_b32 s22, 0x200000
    s_mov_b32 s23, 0x00020000
    v_and_b32 v2, 15, v0
    v_lshrrev_b32 v3, 4, v1
    s_and_b32 s62, s2, 7
    s_lshr_b32 s63, s2, 3
    s_lshl_b32 s66, s62, 5
    s_add_u32 s66, s66, s63
    s_lshr_b32 s64, s62, 1
    s_lshl_b32 s64, s64, 2
    s_lshr_b32 s70, s63, 3
    s_add_u32 s64, s64, s70
    s_and_b32 s65, s62, 1
    s_lshl_b32 s65, s65, 3
    s_and_b32 s70, s63, 7
    s_add_u32 s65, s65, s70
    s_mov_b32 s69, 200000
    s_mov_b32 s78, 0xffff0000
    s_mov_b32 s79, 0x3f803f80
    s_mov_b32 s77, 0x3b000000
    v_lshlrev_b32 v5, 4, v1
    v_lshlrev_b32 v6, 8, v3
    v_lshl_add_u32 v6, v2, 2, v6
    s_lshl_b32 s70, s64, 7
    s_lshl_b32 s71, s67, 5
    s_add_u32 s70, s70, s71
    s_lshl_b32 s71, s65, 1
    s_add_u32 s70, s70, s71
    s_lshl_b32 s76, s70, 10
    v_mov_b32 v14, 0x1610000
    v_lshlrev_b32 v7, 4, v0
    s_lshl_b32 s48, s64, 4
    s_add_u32 s48, s48, s65
    s_lshl_b32 s48, s48, 13
    s_add_u32 s72, s48, 4096
    v_accvgpr_write_b32 a224, -1
    v_accvgpr_write_b32 a225, -1
    v_accvgpr_write_b32 a226, -1
    v_accvgpr_write_b32 a227, -1
    s_lshl_b32 s70, s66, 3
    s_add_u32 s70, s70, 23068672
    v_mov_b32 v79, 0x7ffffff0
    v_mov_b32 v13, s70
    v_cmp_eq_u32 vcc, 0, v0
    s_nop 1
    v_cndmask_b32 v79, v79, v13, vcc
    s_waitcnt lgkmcnt(0)
    buffer_load_dword v100, v14, s[8:11], 0 offen sc1
    buffer_store_dwordx4 a[224:227], v7, s[8:11], s48 offen offset:0 sc1
    buffer_store_dwordx4 a[224:227], v7, s[8:11], s72 offen offset:0 sc1
    buffer_load_dword v86, v6, s[4:7], s76 offen offset:0
    buffer_load_dword v87, v6, s[4:7], s76 offen offset:64
    buffer_load_dword v88, v6, s[4:7], s76 offen offset:128
    buffer_load_dword v89, v6, s[4:7], s76 offen offset:192
    buffer_load_dword v90, v6, s[4:7], s76 offen offset:1024
    buffer_load_dword v91, v6, s[4:7], s76 offen offset:1088
    buffer_load_dword v92, v6, s[4:7], s76 offen offset:1152
    buffer_load_dword v93, v6, s[4:7], s76 offen offset:1216
    v_bfe_u32 v12, v1, 3, 2
    v_lshlrev_b32 v12, 6, v12
    v_lshrrev_b32 v13, 5, v1
    v_add_u32 v12, v12, v13
    v_mul_u32_u24 v102, 514, v12
    v_and_b32 v12, 7, v1
    v_lshl_add_u32 v102, v12, 4, v102
    s_lshr_b32 s70, s66, 6
    s_lshl_b32 s70, s70, 4
    s_bfe_u32 s71, s66, 0x10002
    s_lshl_b32 s71, s71, 3
    s_add_u32 s70, s70, s71
    s_bfe_u32 s71, s66, 0x20003
    s_lshl_b32 s71, s71, 9
    s_add_u32 s70, s70, s71
    s_bfe_u32 s71, s66, 0x10005
    s_lshl_b32 s71, s71, 8
    s_add_u32 s70, s70, s71
    s_lshl_b32 s71, s67, 1
    s_add_u32 s70, s70, s71
    s_mul_i32 s70, s70, 514
    s_and_b32 s71, s66, 3
    s_lshl_b32 s71, s71, 7
    s_add_u32 s70, s70, s71
    s_add_u32 s55, s70, 2
    s_lshl_b32 s70, s66, 2
    s_add_u32 s70, s70, s67
    s_mul_i32 s57, s70, 1792
    s_mov_b32 s60, s57
    v_lshlrev_b32 v103, 7, v1
    v_mov_b32 v13, 0x7ffffff0
    v_cmp_gt_u32 vcc, 14, v1
    s_nop 1
    v_cndmask_b32 v103, v13, v103, vcc
    v_cvt_f32_u32 v210, v2
    v_mul_f32 v210, 0x3d800000, v210
    v_lshlrev_b32 v208, 2, v3
    v_cvt_f32_u32 v208, v208
    v_mul_f32 v208, v208, v210
    v_fract_f32 v209, v208
    v_cos_f32 v200, v209
    v_sin_f32 v204, v209
    v_add_f32 v208, v208, v210
    v_fract_f32 v209, v208
    v_cos_f32 v201, v209
    v_sin_f32 v205, v209
    v_add_f32 v208, v208, v210
    v_fract_f32 v209, v208
    v_cos_f32 v202, v209
    v_sin_f32 v206, v209
    v_add_f32 v208, v208, v210
    v_fract_f32 v209, v208
    v_cos_f32 v203, v209
    v_sin_f32 v207, v209
    v_cvt_pk_bf16_f32 v82, v200, v201
    v_cvt_pk_bf16_f32 v83, v202, v203
    v_cvt_pk_bf16_f32 v84, v204, v205
    v_cvt_pk_bf16_f32 v85, v206, v207
    v_cvt_pk_bf16_f32 v80, -v204, -v205
    v_cvt_pk_bf16_f32 v81, -v206, -v207
    v_cvt_f32_u32 v210, v2
    v_mul_f32 v210, 0x3b000000, v210
    v_lshlrev_b32 v208, 3, v3
    v_cvt_f32_u32 v208, v208
    v_mul_f32 v208, v208, v210
    v_fract_f32 v209, v208
    v_cos_f32 v56, v209
    v_sin_f32 v64, v209
    v_fma_f32 v208, v210, 2.0, v208
    v_fract_f32 v209, v208
    v_cos_f32 v57, v209
    v_sin_f32 v65, v209
    v_fma_f32 v208, v210, 2.0, v208
    v_fract_f32 v209, v208
    v_cos_f32 v58, v209
    v_sin_f32 v66, v209
    v_fma_f32 v208, v210, 2.0, v208
    v_fract_f32 v209, v208
    v_cos_f32 v59, v209
    v_sin_f32 v67, v209
    v_lshlrev_b32 v208, 3, v3
    v_add_u32 v208, 1, v208
    v_cvt_f32_u32 v208, v208
    v_mul_f32 v208, v208, v210
    v_fract_f32 v209, v208
    v_cos_f32 v60, v209
    v_sin_f32 v68, v209
    buffer_load_dwordx4 v[248:251], v102, s[24:27], s55 offen
    buffer_load_dwordx4 v[252:255], v102, s[28:31], s55 offen
    v_fma_f32 v208, v210, 2.0, v208
    v_fract_f32 v209, v208
    v_cos_f32 v61, v209
    v_sin_f32 v69, v209
    v_fma_f32 v208, v210, 2.0, v208
    v_fract_f32 v209, v208
    v_cos_f32 v62, v209
    v_sin_f32 v70, v209
    v_fma_f32 v208, v210, 2.0, v208
    v_fract_f32 v209, v208
    v_cos_f32 v63, v209
    v_sin_f32 v71, v209
    v_lshlrev_b32 v210, 1, v2
    v_cvt_f32_u32 v210, v210
    v_mul_f32 v210, 0x3d000000, v210
    v_lshlrev_b32 v208, 3, v3
    v_cvt_f32_u32 v208, v208
    v_mul_f32 v208, v208, v210
    v_fract_f32 v209, v208
    v_cos_f32 v200, v209
    v_sin_f32 v204, v209
    v_fma_f32 v208, v210, 2.0, v208
    v_fract_f32 v209, v208
    v_cos_f32 v201, v209
    v_sin_f32 v205, v209
    v_fma_f32 v208, v210, 2.0, v208
    v_fract_f32 v209, v208
    v_cos_f32 v202, v209
    v_sin_f32 v206, v209
    v_fma_f32 v208, v210, 2.0, v208
    v_fract_f32 v209, v208
    v_cos_f32 v203, v209
    v_sin_f32 v207, v209
    v_cvt_pk_bf16_f32 v18, v200, v201
    v_cvt_pk_bf16_f32 v19, v202, v203
    v_cvt_pk_bf16_f32 v20, v204, v205
    v_cvt_pk_bf16_f32 v21, v206, v207
    v_cvt_pk_bf16_f32 v16, -v204, -v205
    v_cvt_pk_bf16_f32 v17, -v206, -v207
    v_mov_b64 v[22:23], v[18:19]
    v_mov_b64 v[24:25], v[16:17]
    v_lshlrev_b32 v208, 3, v3
    v_add_u32 v208, 1, v208
    v_cvt_f32_u32 v208, v208
    v_mul_f32 v208, v208, v210
    v_fract_f32 v209, v208
    v_cos_f32 v200, v209
    v_sin_f32 v204, v209
    v_fma_f32 v208, v210, 2.0, v208
    v_fract_f32 v209, v208
    v_cos_f32 v201, v209
    v_sin_f32 v205, v209
    v_fma_f32 v208, v210, 2.0, v208
    v_fract_f32 v209, v208
    v_cos_f32 v202, v209
    v_sin_f32 v206, v209
    v_fma_f32 v208, v210, 2.0, v208
    v_fract_f32 v209, v208
    v_cos_f32 v203, v209
    v_sin_f32 v207, v209
    v_cvt_pk_bf16_f32 v28, v200, v201
    v_cvt_pk_bf16_f32 v29, v202, v203
    v_cvt_pk_bf16_f32 v30, v204, v205
    v_cvt_pk_bf16_f32 v31, v206, v207
    v_cvt_pk_bf16_f32 v26, -v204, -v205
    v_cvt_pk_bf16_f32 v27, -v206, -v207
    v_mov_b64 v[32:33], v[28:29]
    v_mov_b64 v[34:35], v[26:27]
    v_lshlrev_b32 v210, 1, v2
    v_add_u32 v210, 1, v210
    v_cvt_f32_u32 v210, v210
    v_mul_f32 v210, 0x3d000000, v210
    v_lshlrev_b32 v208, 3, v3
    v_cvt_f32_u32 v208, v208
    v_mul_f32 v208, v208, v210
    v_fract_f32 v209, v208
    v_cos_f32 v200, v209
    v_sin_f32 v204, v209
    v_fma_f32 v208, v210, 2.0, v208
    v_fract_f32 v209, v208
    v_cos_f32 v201, v209
    v_sin_f32 v205, v209
    v_fma_f32 v208, v210, 2.0, v208
    v_fract_f32 v209, v208
    v_cos_f32 v202, v209
    v_sin_f32 v206, v209
    v_fma_f32 v208, v210, 2.0, v208
    v_fract_f32 v209, v208
    v_cos_f32 v203, v209
    v_sin_f32 v207, v209
    v_cvt_pk_bf16_f32 v38, v200, v201
    v_cvt_pk_bf16_f32 v39, v202, v203
    v_cvt_pk_bf16_f32 v40, v204, v205
    v_cvt_pk_bf16_f32 v41, v206, v207
    v_cvt_pk_bf16_f32 v36, -v204, -v205
    v_cvt_pk_bf16_f32 v37, -v206, -v207
    v_mov_b64 v[42:43], v[38:39]
    v_mov_b64 v[44:45], v[36:37]
    v_lshlrev_b32 v208, 3, v3
    v_add_u32 v208, 1, v208
    v_cvt_f32_u32 v208, v208
    v_mul_f32 v208, v208, v210
    v_fract_f32 v209, v208
    v_cos_f32 v200, v209
    v_sin_f32 v204, v209
    v_fma_f32 v208, v210, 2.0, v208
    v_fract_f32 v209, v208
    v_cos_f32 v201, v209
    v_sin_f32 v205, v209
    v_fma_f32 v208, v210, 2.0, v208
    v_fract_f32 v209, v208
    v_cos_f32 v202, v209
    v_sin_f32 v206, v209
    v_fma_f32 v208, v210, 2.0, v208
    v_fract_f32 v209, v208
    v_cos_f32 v203, v209
    v_sin_f32 v207, v209
    v_cvt_pk_bf16_f32 v48, v200, v201
    v_cvt_pk_bf16_f32 v49, v202, v203
    v_cvt_pk_bf16_f32 v50, v204, v205
    v_cvt_pk_bf16_f32 v51, v206, v207
    v_cvt_pk_bf16_f32 v46, -v204, -v205
    v_cvt_pk_bf16_f32 v47, -v206, -v207
    v_mov_b64 v[52:53], v[48:49]
    v_mov_b64 v[54:55], v[46:47]
    buffer_load_dword a228, v103, s[12:15], s57 offen
    buffer_load_dword a229, v103, s[16:19], s60 offen
    s_waitcnt vmcnt(12)
    v_readfirstlane_b32 s68, v100
    s_add_u32 s59, s68, 1
    s_xor_b32 s47, s68, 0x2545f491
    s_mul_i32 s47, s47, 0x9e3779b1
    s_add_u32 s46, s68, 0x5bd1e995
    s_mov_b32 s68, s46
    v_mov_b32 v13, s68
    s_barrier
    buffer_store_dword v13, v79, s[8:11], 0 offen sc1
    s_lshl_b32 s70, s67, 10
    s_add_u32 s70, s70, 155648
    v_add_u32 v6, s70, v5
    v_lshrrev_b32 v12, 1, v2
    v_lshlrev_b32 v9, 15, v12
    v_and_b32 v12, 1, v1
    v_lshl_add_u32 v9, v12, 6, v9
    v_lshl_add_u32 v9, v3, 4, v9
    s_and_b32 s70, s66, 3
    s_lshl_b32 s70, s70, 2
    s_add_u32 s70, s70, s67
    s_lshl_b32 s70, s70, 18
    s_lshr_b32 s74, s66, 5
    s_lshl_b32 s74, s74, 12
    s_add_u32 s70, s70, s74
    s_bfe_u32 s74, s66, 0x30002
    s_lshl_b32 s74, s74, 8
    s_add_u32 s70, s70, s74
    s_add_u32 s50, s70, 4194304
    v_lshlrev_b32 v4, 9, v3
    v_bfe_u32 v12, v1, 2, 2
    v_lshl_add_u32 v4, v12, 7, v4
    v_and_b32 v12, 3, v1
    v_lshl_add_u32 v4, v12, 3, v4
    s_lshl_b32 s70, s67, 5
    s_add_u32 s70, s70, 155648
    v_add_u32 v4, s70, v4
    s_lshl_b32 s51, s64, 17
    s_lshr_b32 s74, s65, 2
    s_lshl_b32 s74, s74, 15
    s_add_u32 s51, s51, s74
    s_and_b32 s74, s65, 3
    s_lshl_b32 s74, s74, 7
    s_add_u32 s51, s51, s74
    s_add_u32 s51, s51, 10485760
    s_lshl_b32 s74, s64, 2
    s_add_u32 s74, s74, s67
    s_lshl_b32 s74, s74, 4
    s_add_u32 s74, s74, s65
    s_mul_i32 s74, s74, 7168
    s_add_u32 s52, s74, 14680064
    v_lshrrev_b32 v12, 5, v1
    v_lshlrev_b32 v10, 12, v12
    v_lshlrev_b32 v11, 9, v12
    v_bfe_u32 v12, v1, 2, 2
    v_lshl_add_u32 v10, v12, 10, v10
    v_lshl_add_u32 v11, v12, 6, v11
    v_bfe_u32 v12, v1, 4, 1
    v_lshl_add_u32 v10, v12, 6, v10
    v_lshl_add_u32 v11, v12, 5, v11
    v_and_b32 v12, 3, v1
    v_lshl_add_u32 v10, v12, 4, v10
    v_lshl_add_u32 v11, v12, 3, v11
    s_lshl_b32 s100, s67, 13
    s_add_u32 s100, s100, 114688
    v_add_u32 v11, s100, v11
    s_mul_i32 s101, s67, 458752
    s_lshr_b32 s74, s65, 3
    s_lshl_b32 s74, s74, 2
    s_and_b32 s62, s65, 3
    s_add_u32 s74, s74, s62
    s_lshl_b32 s74, s74, 7
    s_add_u32 s101, s101, s74
    s_mul_i32 s80, s67, 28672
    s_mul_i32 s81, s67, 458752
    s_mul_i32 s74, s65, 224
    s_add_u32 s81, s81, s74
    v_bfe_u32 v12, v1, 4, 1
    v_lshlrev_b32 v8, 9, v12
    v_lshl_add_u32 v8, v2, 5, v8
    v_lshrrev_b32 v12, 5, v1
    v_lshl_add_u32 v8, v12, 4, v8
    s_lshl_b32 s74, s67, 11
    s_lshl_b32 s49, s66, 13
    s_add_u32 s74, s74, s49
    s_add_u32 s49, s74, 8388608
    s_and_b32 s62, s64, 3
    s_mov_b32 s63, s62
    s_mov_b32 s62, 0
    s_mov_b32 s63, 0
    s_mov_b32 s3, s63
    s_add_u32 s74, s62, 0
    s_and_b32 s74, s74, 3
    s_mul_i32 s28, s74, 7168
    s_add_u32 s74, s63, 0
    s_and_b32 s74, s74, 3
    s_mul_i32 s74, s74, 114688
    s_add_u32 s24, s74, s101
    s_add_u32 s74, s62, 1
    s_and_b32 s74, s74, 3
    s_mul_i32 s29, s74, 7168
    s_add_u32 s74, s63, 1
    s_and_b32 s74, s74, 3
    s_mul_i32 s74, s74, 114688
    s_add_u32 s25, s74, s101
    s_add_u32 s74, s62, 2
    s_and_b32 s74, s74, 3
    s_mul_i32 s30, s74, 7168
    s_add_u32 s74, s63, 2
    s_and_b32 s74, s74, 3
    s_mul_i32 s74, s74, 114688
    s_add_u32 s26, s74, s101
    s_add_u32 s74, s62, 3
    s_and_b32 s74, s74, 3
    s_mul_i32 s31, s74, 7168
    s_add_u32 s74, s63, 3
    s_and_b32 s74, s74, 3
    s_mul_i32 s74, s74, 114688
    s_add_u32 s27, s74, s101
    s_lshl_b32 s62, s28, 4
    s_add_u32 s62, s62, s81
    s_lshl_b32 s63, s29, 4
    s_add_u32 s63, s63, s81
    s_lshl_b32 s74, s30, 4
    s_nop 0
    s_add_u32 s28, s28, s80
    s_add_u32 s29, s29, s80
    s_add_u32 s30, s30, s80
    s_add_u32 s31, s31, s80
    s_sub_u32 s80, s31, s80
    s_lshl_b32 s80, s80, 4
    s_add_u32 s74, s74, s81
    s_add_u32 s81, s80, s81
    s_mov_b32 s80, s74
    s_waitcnt vmcnt(5)
    v_dot2_f32_bf16 v110, v86, s79, 0
    v_dot2_f32_bf16 v111, v86, v86, 0
    v_dot2_f32_bf16 v112, v90, s79, 0
    v_dot2_f32_bf16 v113, v90, v90, 0
    v_dot2_f32_bf16 v110, v87, s79, v110
    v_dot2_f32_bf16 v111, v87, v87, v111
    v_dot2_f32_bf16 v112, v91, s79, v112
    v_dot2_f32_bf16 v113, v91, v91, v113
    v_dot2_f32_bf16 v110, v88, s79, v110
    v_dot2_f32_bf16 v111, v88, v88, v111
    v_dot2_f32_bf16 v112, v92, s79, v112
    v_dot2_f32_bf16 v113, v92, v92, v113
    v_dot2_f32_bf16 v110, v89, s79, v110
    v_dot2_f32_bf16 v111, v89, v89, v111
    v_dot2_f32_bf16 v112, v93, s79, v112
    v_dot2_f32_bf16 v113, v93, v93, v113
    v_lshlrev_b32 v130, 16, v86
    v_and_b32 v134, s78, v86
    s_add_u32 m0, s100, 0
    s_add_u32 s74, s24, 0
    buffer_load_dwordx4 v10, s[16:19], s74 offen lds
    v_permlane32_swap_b32 v110, v112
    v_permlane32_swap_b32 v111, v113
    v_add_f32 v110, v110, v112
    v_add_f32 v111, v111, v113
    v_lshlrev_b32 v131, 16, v87
    v_and_b32 v135, s78, v87
    v_permlane16_swap_b32 v110, v111
    v_add_f32 v110, v110, v111
    v_lshlrev_b32 v132, 16, v88
    v_and_b32 v136, s78, v88
    v_add_f32_dpp v110, v110, v110 row_ror:8 row_mask:0xf bank_mask:0xf
    v_lshlrev_b32 v133, 16, v89
    v_and_b32 v137, s78, v89
    v_add_f32_dpp v110, v110, v110 row_ror:4 row_mask:0xf bank_mask:0xf
    v_lshlrev_b32 v138, 16, v90
    s_add_u32 m0, s100, 1024
    s_add_u32 s74, s24, 8192
    buffer_load_dwordx4 v10, s[16:19], s74 offen lds
    v_and_b32 v142, s78, v90
    v_add_f32_dpp v110, v110, v110 row_ror:2 row_mask:0xf bank_mask:0xf
    v_lshlrev_b32 v139, 16, v91
    v_and_b32 v143, s78, v91
    v_add_f32_dpp v110, v110, v110 row_ror:1 row_mask:0xf bank_mask:0xf
    v_mov_b32 v111, v110
    v_lshlrev_b32 v140, 16, v92
    v_and_b32 v144, s78, v92
    v_permlane16_swap_b32 v110, v111
    v_mul_f32 v110, 0x3b000000, v110
    v_mul_f32 v112, v110, v110
    v_fma_f32 v111, v111, s77, -v112
    v_max_f32 v111, 0, v111
    v_add_f32 v112, 0x3727c5ac, v111
    v_rsq_f32 v114, v112
    v_lshlrev_b32 v141, 16, v93
    s_add_u32 m0, s100, 2048
    s_add_u32 s74, s24, 16384
    buffer_load_dwordx4 v10, s[16:19], s74 offen lds
    v_mul_f32 v115, -v110, v114
    v_mov_b32 v116, v114
    v_mov_b32 v117, v115
    v_and_b32 v145, s78, v93
    v_permlane32_swap_b32 v114, v116
    v_permlane32_swap_b32 v115, v117
    v_pk_fma_f32 v[130:131], v[130:131], v[114:115], v[114:115] op_sel:[0,0,1] op_sel_hi:[1,0,1]
    v_pk_fma_f32 v[132:133], v[132:133], v[114:115], v[114:115] op_sel:[0,0,1] op_sel_hi:[1,0,1]
    v_pk_fma_f32 v[134:135], v[134:135], v[114:115], v[114:115] op_sel:[0,0,1] op_sel_hi:[1,0,1]
    v_pk_fma_f32 v[136:137], v[136:137], v[114:115], v[114:115] op_sel:[0,0,1] op_sel_hi:[1,0,1]
    v_pk_fma_f32 v[138:139], v[138:139], v[116:117], v[116:117] op_sel:[0,0,1] op_sel_hi:[1,0,1]
    v_pk_fma_f32 v[140:141], v[140:141], v[116:117], v[116:117] op_sel:[0,0,1] op_sel_hi:[1,0,1]
    v_pk_fma_f32 v[142:143], v[142:143], v[116:117], v[116:117] op_sel:[0,0,1] op_sel_hi:[1,0,1]
    v_pk_fma_f32 v[144:145], v[144:145], v[116:117], v[116:117] op_sel:[0,0,1] op_sel_hi:[1,0,1]
    v_cvt_pk_bf16_f32 v122, v130, v131
    s_add_u32 m0, s100, 3072
    s_add_u32 s74, s24, 24576
    buffer_load_dwordx4 v10, s[16:19], s74 offen lds
    v_cvt_pk_bf16_f32 v123, v132, v133
    v_cvt_pk_bf16_f32 v124, v138, v139
    v_cvt_pk_bf16_f32 v125, v140, v141
    v_cvt_pk_bf16_f32 v126, v134, v135
    v_cvt_pk_bf16_f32 v127, v136, v137
    v_cvt_pk_bf16_f32 v128, v142, v143
    v_cvt_pk_bf16_f32 v129, v144, v145
    v_mfma_f32_16x16x32_bf16 v[170:173], v[122:125], v[82:85], 0
    v_mfma_f32_16x16x32_bf16 v[178:181], v[122:125], v[80:83], 0
    v_mfma_f32_16x16x32_bf16 v[174:177], v[126:129], v[82:85], 0
    v_mfma_f32_16x16x32_bf16 v[182:185], v[126:129], v[80:83], 0
    v_lshlrev_b32 v14, 9, v3
    v_lshl_add_u32 v14, v2, 2, v14
    s_lshl_b32 s70, s67, 11
    s_add_u32 s70, s70, 147456
    s_add_u32 m0, s100, 4096
    s_add_u32 s74, s24, 32768
    buffer_load_dwordx4 v10, s[16:19], s74 offen lds
    v_add_u32 v14, s70, v14
    v_lshrrev_b32 v12, 1, v0
    v_add_u32 v15, 1, v12
    v_sub_u32 v12, 511, v12
    s_lshl_b32 s54, s67, 9
    s_add_u32 s54, s54, 23068672
    v_lshlrev_b32 v213, 3, v1
    v_pk_mul_f32 v[186:187], v[178:179], v[64:65]
    v_pk_mul_f32 v[188:189], v[170:171], v[64:65]
    v_pk_fma_f32 v[130:131], v[170:171], v[56:57], v[186:187]
    v_pk_fma_f32 v[138:139], v[178:179], v[56:57], v[188:189] neg_lo:[0,0,1] neg_hi:[0,0,1]
    v_pk_mul_f32 v[186:187], v[180:181], v[66:67]
    v_pk_mul_f32 v[188:189], v[172:173], v[66:67]
    v_pk_fma_f32 v[132:133], v[172:173], v[58:59], v[186:187]
    v_pk_fma_f32 v[140:141], v[180:181], v[58:59], v[188:189] neg_lo:[0,0,1] neg_hi:[0,0,1]
    v_pk_mul_f32 v[186:187], v[182:183], v[68:69]
    s_add_u32 m0, s100, 5120
    s_add_u32 s74, s24, 40960
    buffer_load_dwordx4 v10, s[16:19], s74 offen lds
    v_pk_mul_f32 v[188:189], v[174:175], v[68:69]
    v_pk_fma_f32 v[134:135], v[174:175], v[60:61], v[186:187]
    v_pk_fma_f32 v[142:143], v[182:183], v[60:61], v[188:189] neg_lo:[0,0,1] neg_hi:[0,0,1]
    v_pk_mul_f32 v[186:187], v[184:185], v[70:71]
    v_pk_mul_f32 v[188:189], v[176:177], v[70:71]
    v_pk_fma_f32 v[136:137], v[176:177], v[62:63], v[186:187]
    v_pk_fma_f32 v[144:145], v[184:185], v[62:63], v[188:189] neg_lo:[0,0,1] neg_hi:[0,0,1]
    v_cvt_pk_bf16_f32 v122, v130, v131
    v_cvt_pk_bf16_f32 v123, v132, v133
    v_cvt_pk_bf16_f32 v124, v138, v139
    v_cvt_pk_bf16_f32 v125, v140, v141
    v_cvt_pk_bf16_f32 v126, v134, v135
    v_cvt_pk_bf16_f32 v127, v136, v137
    v_cvt_pk_bf16_f32 v128, v142, v143
    v_cvt_pk_bf16_f32 v129, v144, v145
    s_add_u32 m0, s100, 6144
    s_add_u32 s74, s24, 49152
    buffer_load_dwordx4 v10, s[16:19], s74 offen lds
    v_mfma_f32_16x16x32_bf16 v[170:173], v[18:21], v[122:125], 0
    v_and_b32 v13, 1, v0
    v_cmp_eq_u32 vcc, 1, v13
    v_mfma_f32_16x16x32_bf16 v[178:181], v[16:19], v[122:125], 0
    v_add_u32 v130, 128, v15
    v_subrev_u32 v131, 128, v12
    v_mfma_f32_16x16x32_bf16 v[174:177], v[38:41], v[122:125], 0
    v_cndmask_b32 v15, v15, v12, vcc
    v_cndmask_b32 v12, v130, v131, vcc
    v_mfma_f32_16x16x32_bf16 v[182:185], v[36:39], v[122:125], 0
    v_lshlrev_b32 v15, 2, v15
    v_lshlrev_b32 v12, 2, v12
    v_mfma_f32_16x16x32_bf16 v[170:173], v[28:31], v[126:129], v[170:173]
    v_add_u32 v15, 147456, v15
    v_add_u32 v12, 147456, v12
    s_add_u32 m0, s100, 7168
    s_add_u32 s74, s24, 57344
    buffer_load_dwordx4 v10, s[16:19], s74 offen lds
    v_mfma_f32_16x16x32_bf16 v[178:181], v[26:29], v[126:129], v[178:181]
    v_mfma_f32_16x16x32_bf16 v[174:177], v[48:51], v[126:129], v[174:177]
    v_mfma_f32_16x16x32_bf16 v[182:185], v[46:49], v[126:129], v[182:185]
    s_nop 5
    v_cvt_pk_bf16_f32 v130, v170, v178
    ds_write_b32 v14, v130 offset:0
    v_cvt_pk_bf16_f32 v131, v171, v179
    ds_write_b32 v14, v131 offset:128
    v_cvt_pk_bf16_f32 v132, v172, v180
    ds_write_b32 v14, v132 offset:256
    v_cvt_pk_bf16_f32 v133, v173, v181
    ds_write_b32 v14, v133 offset:384
    v_cvt_pk_bf16_f32 v134, v174, v182
    ds_write_b32 v14, v134 offset:64
    v_cvt_pk_bf16_f32 v135, v175, v183
    ds_write_b32 v14, v135 offset:192
    v_cvt_pk_bf16_f32 v136, v176, v184
    ds_write_b32 v14, v136 offset:320
    v_cvt_pk_bf16_f32 v137, v177, v185
    ds_write_b32 v14, v137 offset:448
    s_add_u32 s71, s48, 4096
    s_waitcnt vmcnt(11)
    ds_write_b128 v6, v[248:251]
    ds_write_b128 v6, v[252:255] offset:4096
    v_mov_b64 v[226:227], s[46:47]
    v_mov_b64 v[230:231], s[46:47]
    v_mov_b64 v[234:235], s[46:47]
    v_mov_b64 v[238:239], s[46:47]
    s_waitcnt lgkmcnt(0)
    s_barrier
    buffer_load_dword v212, v213, s[8:11], s54 offen sc1
    ds_read2st64_b32 v[104:105], v15 offset0:0 offset1:8
    ds_read2st64_b32 v[106:107], v15 offset0:16 offset1:24
    ds_read2st64_b32 v[108:109], v12 offset0:0 offset1:8
    ds_read2st64_b32 v[110:111], v12 offset0:16 offset1:24
    ds_read_b64_tr_b16 v[224:225], v4 offset:0
    ds_read_b64_tr_b16 v[228:229], v4 offset:4096
    ds_read_b64_tr_b16 v[232:233], v4 offset:2048
    ds_read_b64_tr_b16 v[236:237], v4 offset:6144
    s_waitcnt lgkmcnt(6)
    buffer_store_dwordx4 v[104:107], v7, s[8:11], s48 offen sc1
    s_waitcnt lgkmcnt(4)
    buffer_store_dwordx4 v[108:111], v7, s[8:11], s71 offen sc1
    s_waitcnt lgkmcnt(3)
    buffer_store_dwordx4 v[224:227], v9, s[8:11], s50 offen offset:0 sc1
    s_waitcnt lgkmcnt(2)
    buffer_store_dwordx4 v[228:231], v9, s[8:11], s50 offen offset:2048 sc1
    s_waitcnt lgkmcnt(1)
    buffer_store_dwordx4 v[232:235], v9, s[8:11], s50 offen offset:128 sc1
    s_waitcnt lgkmcnt(0)
    buffer_store_dwordx4 v[236:239], v9, s[8:11], s50 offen offset:2176 sc1
    v_and_b32 v12, 31, v1
    v_lshrrev_b32 v13, 5, v1
    v_lshlrev_b32 v4, 13, v12
    v_lshl_add_u32 v4, v13, 4, v4
    s_lshl_b32 s70, s67, 19
    s_lshl_b32 s71, s66, 5
    s_add_u32 s70, s70, s71
    s_add_u32 s71, s70, 262144
    v_lshrrev_b32 v12, 3, v0
    v_lshlrev_b32 v7, 9, v12
    v_and_b32 v12, 7, v0
    v_lshl_add_u32 v7, v12, 4, v7
    s_add_u32 s61, s51, 16384
    s_add_u32 s58, s52, 4096
    s_lshl_b32 s73, s67, 4
    v_add_u32 v244, s73, v2
    v_cvt_f32_u32 v244, v244
    v_mul_f32 v244, 0x3c800000, v244
    s_movk_i32 s75, 1171
    v_add_u32 v216, 0, v1
    v_mul_u32_u24 v217, s75, v216
    v_lshrrev_b32 v217, 16, v217
    v_mul_u32_u24 v218, 56, v217
    v_sub_u32 v218, v216, v218
    v_cmp_le_u32 s[44:45], 48, v218
    v_bfe_u32 v219, v218, 2, 2
    v_bfe_u32 v221, v218, 1, 2
    v_cndmask_b32 v219, v219, v221, s[44:45]
    v_and_b32 v221, 3, v218
    v_and_b32 v216, 1, v218
    v_cndmask_b32 v221, v221, v216, s[44:45]
    v_lshrrev_b32 v218, 4, v218
    v_lshl_add_u32 v221, v218, 2, v221
    v_lshrrev_b32 v216, 1, v217
    v_lshl_add_u32 v219, v216, 2, v219
    v_and_b32 v216, 1, v217
    v_lshl_add_u32 v219, v216, 4, v219
    v_mul_u32_u24 v219, 3584, v219
    v_lshlrev_b32 v245, 2, v3
    v_cvt_f32_u32 v245, v245
    v_mul_f32 v242, v245, v244
    v_fract_f32 v243, v242
    v_cos_f32 v240, v243
    v_lshl_add_u32 v72, v221, 4, v219
    v_add_u32 v216, 64, v1
    v_mul_u32_u24 v217, s75, v216
    v_lshrrev_b32 v217, 16, v217
    v_mul_u32_u24 v218, 56, v217
    v_sub_u32 v218, v216, v218
    v_cmp_le_u32 s[44:45], 48, v218
    v_bfe_u32 v219, v218, 2, 2
    v_bfe_u32 v221, v218, 1, 2
    v_cndmask_b32 v219, v219, v221, s[44:45]
    v_and_b32 v221, 3, v218
    v_and_b32 v216, 1, v218
    v_cndmask_b32 v221, v221, v216, s[44:45]
    v_lshrrev_b32 v218, 4, v218
    v_lshl_add_u32 v221, v218, 2, v221
    v_lshrrev_b32 v216, 1, v217
    v_lshl_add_u32 v219, v216, 2, v219
    v_and_b32 v216, 1, v217
    v_lshl_add_u32 v219, v216, 4, v219
    v_mul_u32_u24 v219, 3584, v219
    v_sin_f32 v241, v243
    s_nop 0
    v_cvt_pk_bf16_f32 v80, v240, v241
    v_cvt_pk_bf16_f32 v84, -v241, v240
    v_cvt_pk_bf16_f32 v88, v240, -v241
    v_cvt_pk_bf16_f32 v92, v241, v240
    v_lshl_add_u32 v73, v221, 4, v219
    v_add_u32 v216, 128, v1
    v_mul_u32_u24 v217, s75, v216
    v_lshrrev_b32 v217, 16, v217
    v_mul_u32_u24 v218, 56, v217
    v_sub_u32 v218, v216, v218
    v_cmp_le_u32 s[44:45], 48, v218
    v_bfe_u32 v219, v218, 2, 2
    v_bfe_u32 v221, v218, 1, 2
    v_cndmask_b32 v219, v219, v221, s[44:45]
    v_and_b32 v221, 3, v218
    v_and_b32 v216, 1, v218
    v_cndmask_b32 v221, v221, v216, s[44:45]
    v_lshrrev_b32 v218, 4, v218
    v_lshl_add_u32 v221, v218, 2, v221
    v_lshrrev_b32 v216, 1, v217
    v_lshl_add_u32 v219, v216, 2, v219
    v_and_b32 v216, 1, v217
    v_lshl_add_u32 v219, v216, 4, v219
    v_mul_u32_u24 v219, 3584, v219
    v_add_f32 v242, v242, v244
    v_fract_f32 v243, v242
    v_cos_f32 v240, v243
    v_sin_f32 v241, v243
    s_nop 0
    v_cvt_pk_bf16_f32 v81, v240, v241
    v_lshl_add_u32 v74, v221, 4, v219
    v_add_u32 v216, 192, v1
    v_mul_u32_u24 v217, s75, v216
    v_lshrrev_b32 v217, 16, v217
    v_mul_u32_u24 v218, 56, v217
    v_sub_u32 v218, v216, v218
    v_cmp_le_u32 s[44:45], 48, v218
    v_bfe_u32 v219, v218, 2, 2
    v_bfe_u32 v221, v218, 1, 2
    v_cndmask_b32 v219, v219, v221, s[44:45]
    v_and_b32 v221, 3, v218
    v_and_b32 v216, 1, v218
    v_cndmask_b32 v221, v221, v216, s[44:45]
    v_lshrrev_b32 v218, 4, v218
    v_lshl_add_u32 v221, v218, 2, v221
    v_lshrrev_b32 v216, 1, v217
    v_lshl_add_u32 v219, v216, 2, v219
    v_and_b32 v216, 1, v217
    v_lshl_add_u32 v219, v216, 4, v219
    v_mul_u32_u24 v219, 3584, v219
    v_cvt_pk_bf16_f32 v85, -v241, v240
    v_cvt_pk_bf16_f32 v89, v240, -v241
    v_cvt_pk_bf16_f32 v93, v241, v240
    v_add_f32 v242, v242, v244
    v_fract_f32 v243, v242
    v_lshl_add_u32 v75, v221, 4, v219
    v_add_u32 v216, 256, v1
    v_mul_u32_u24 v217, s75, v216
    v_lshrrev_b32 v217, 16, v217
    v_mul_u32_u24 v218, 56, v217
    v_sub_u32 v218, v216, v218
    v_cmp_le_u32 s[44:45], 48, v218
    v_bfe_u32 v219, v218, 2, 2
    v_bfe_u32 v221, v218, 1, 2
    v_cndmask_b32 v219, v219, v221, s[44:45]
    v_and_b32 v221, 3, v218
    v_and_b32 v216, 1, v218
    v_cndmask_b32 v221, v221, v216, s[44:45]
    v_lshrrev_b32 v218, 4, v218
    v_lshl_add_u32 v221, v218, 2, v221
    v_lshrrev_b32 v216, 1, v217
    v_lshl_add_u32 v219, v216, 2, v219
    v_and_b32 v216, 1, v217
    v_lshl_add_u32 v219, v216, 4, v219
    v_mul_u32_u24 v219, 3584, v219
    v_cos_f32 v240, v243
    v_sin_f32 v241, v243
    s_nop 0
    v_cvt_pk_bf16_f32 v82, v240, v241
    v_cvt_pk_bf16_f32 v86, -v241, v240
    v_lshl_add_u32 v76, v221, 4, v219
    v_add_u32 v216, 320, v1
    v_mul_u32_u24 v217, s75, v216
    v_lshrrev_b32 v217, 16, v217
    v_mul_u32_u24 v218, 56, v217
    v_sub_u32 v218, v216, v218
    v_cmp_le_u32 s[44:45], 48, v218
    v_bfe_u32 v219, v218, 2, 2
    v_bfe_u32 v221, v218, 1, 2
    v_cndmask_b32 v219, v219, v221, s[44:45]
    v_and_b32 v221, 3, v218
    v_and_b32 v216, 1, v218
    v_cndmask_b32 v221, v221, v216, s[44:45]
    v_lshrrev_b32 v218, 4, v218
    v_lshl_add_u32 v221, v218, 2, v221
    v_lshrrev_b32 v216, 1, v217
    v_lshl_add_u32 v219, v216, 2, v219
    v_and_b32 v216, 1, v217
    v_lshl_add_u32 v219, v216, 4, v219
    v_mul_u32_u24 v219, 3584, v219
    v_cvt_pk_bf16_f32 v90, v240, -v241
    v_cvt_pk_bf16_f32 v94, v241, v240
    v_add_f32 v242, v242, v244
    v_fract_f32 v243, v242
    v_cos_f32 v240, v243
    v_lshl_add_u32 v77, v221, 4, v219
    v_add_u32 v216, 384, v1
    v_mul_u32_u24 v217, s75, v216
    v_lshrrev_b32 v217, 16, v217
    v_mul_u32_u24 v218, 56, v217
    v_sub_u32 v218, v216, v218
    v_cmp_le_u32 s[44:45], 48, v218
    v_bfe_u32 v219, v218, 2, 2
    v_bfe_u32 v221, v218, 1, 2
    v_cndmask_b32 v219, v219, v221, s[44:45]
    v_and_b32 v221, 3, v218
    v_and_b32 v216, 1, v218
    v_cndmask_b32 v221, v221, v216, s[44:45]
    v_lshrrev_b32 v218, 4, v218
    v_lshl_add_u32 v221, v218, 2, v221
    v_lshrrev_b32 v216, 1, v217
    v_lshl_add_u32 v219, v216, 2, v219
    v_and_b32 v216, 1, v217
    v_lshl_add_u32 v219, v216, 4, v219
    v_mul_u32_u24 v219, 3584, v219
    v_sin_f32 v241, v243
    s_nop 0
    v_cvt_pk_bf16_f32 v83, v240, v241
    v_cvt_pk_bf16_f32 v87, -v241, v240
    v_cvt_pk_bf16_f32 v91, v240, -v241
    v_cvt_pk_bf16_f32 v95, v241, v240
    v_lshl_add_u32 v78, v221, 4, v219
    v_add_f32 v245, 0x41800000, v245
    v_mul_f32 v242, v245, v244
    v_fract_f32 v243, v242
    v_cos_f32 v240, v243
    v_sin_f32 v241, v243
    s_add_u32 m0, s28, 0
    s_nop 0
    buffer_load_dwordx4 v72, s[12:15], s62 offen lds
    v_cvt_pk_bf16_f32 v96, v240, v241
    v_cvt_pk_bf16_f32 v100, -v241, v240
    v_cvt_pk_bf16_f32 v104, v240, -v241
    v_cvt_pk_bf16_f32 v108, v241, v240
    v_add_f32 v242, v242, v244
    s_add_u32 m0, s28, 1024
    s_nop 0
    buffer_load_dwordx4 v73, s[12:15], s62 offen lds
    v_fract_f32 v243, v242
    v_cos_f32 v240, v243
    v_sin_f32 v241, v243
    s_nop 0
    v_cvt_pk_bf16_f32 v97, v240, v241
    v_cvt_pk_bf16_f32 v101, -v241, v240
    v_cvt_pk_bf16_f32 v105, v240, -v241
    v_cvt_pk_bf16_f32 v109, v241, v240
    v_add_f32 v242, v242, v244
    v_fract_f32 v243, v242
    v_cos_f32 v240, v243
    v_sin_f32 v241, v243
    s_nop 0
    v_cvt_pk_bf16_f32 v98, v240, v241
    v_cvt_pk_bf16_f32 v102, -v241, v240
    v_cvt_pk_bf16_f32 v106, v240, -v241
    v_cvt_pk_bf16_f32 v110, v241, v240
    v_add_f32 v242, v242, v244
    v_fract_f32 v243, v242
    v_cos_f32 v240, v243
    v_sin_f32 v241, v243
    s_waitcnt vmcnt(8)
    v_cmp_ne_u32 vcc, s68, v212
    s_cbranch_vccnz L_retry_1
L_cont_2:
    s_barrier
    s_waitcnt vmcnt(6)
    buffer_load_dwordx4 v[192:195], v4, s[8:11], s70 offen sc1
    buffer_load_dwordx4 v[196:199], v4, s[8:11], s71 offen sc1
    v_cvt_pk_bf16_f32 v99, v240, v241
    v_cvt_pk_bf16_f32 v103, -v241, v240
    v_cvt_pk_bf16_f32 v107, v240, -v241
    v_cvt_pk_bf16_f32 v111, v241, v240
    v_add_f32 v245, 0x41800000, v245
    v_mul_f32 v242, v245, v244
    v_fract_f32 v243, v242
    v_cos_f32 v240, v243
    v_sin_f32 v241, v243
    buffer_store_dwordx4 a[224:227], v8, s[8:11], s49 offen offset:0 sc1
    v_cvt_pk_bf16_f32 v112, v240, v241
    v_cvt_pk_bf16_f32 v116, -v241, v240
    v_cvt_pk_bf16_f32 v120, v240, -v241
    v_cvt_pk_bf16_f32 v124, v241, v240
    v_add_f32 v242, v242, v244
    v_fract_f32 v243, v242
    v_cos_f32 v240, v243
    v_sin_f32 v241, v243
    s_nop 0
    v_cvt_pk_bf16_f32 v113, v240, v241
    buffer_store_dwordx4 a[224:227], v8, s[8:11], s49 offen offset:1024 sc1
    v_cvt_pk_bf16_f32 v117, -v241, v240
    v_cvt_pk_bf16_f32 v121, v240, -v241
    v_cvt_pk_bf16_f32 v125, v241, v240
    v_add_f32 v242, v242, v244
    v_fract_f32 v243, v242
    v_cos_f32 v240, v243
    v_sin_f32 v241, v243
    s_nop 0
    v_cvt_pk_bf16_f32 v114, v240, v241
    v_cvt_pk_bf16_f32 v118, -v241, v240
    buffer_store_dwordx4 a[224:227], v7, s[8:11], s51 offen offset:0 sc1
    v_cvt_pk_bf16_f32 v122, v240, -v241
    v_cvt_pk_bf16_f32 v126, v241, v240
    v_add_f32 v242, v242, v244
    v_fract_f32 v243, v242
    v_cos_f32 v240, v243
    v_sin_f32 v241, v243
    s_nop 0
    v_cvt_pk_bf16_f32 v115, v240, v241
    v_cvt_pk_bf16_f32 v119, -v241, v240
    v_cvt_pk_bf16_f32 v123, v240, -v241
    v_cvt_pk_bf16_f32 v127, v241, v240
    buffer_store_dwordx4 a[224:227], v7, s[8:11], s61 offen offset:0 sc1
    v_add_f32 v245, 0x41800000, v245
    v_mul_f32 v242, v245, v244
    v_fract_f32 v243, v242
    v_cos_f32 v240, v243
    v_sin_f32 v241, v243
    s_nop 0
    v_cvt_pk_bf16_f32 v128, v240, v241
    v_cvt_pk_bf16_f32 v132, -v241, v240
    v_cvt_pk_bf16_f32 v136, v240, -v241
    v_cvt_pk_bf16_f32 v140, v241, v240
    ds_read_b64_tr_b16 a[0:1], v11 offset:0
    ds_read_b64_tr_b16 a[2:3], v11 offset:1024
    ds_read_b64_tr_b16 a[4:5], v11 offset:256
    ds_read_b64_tr_b16 a[6:7], v11 offset:1280
    v_add_f32 v242, v242, v244
    v_fract_f32 v243, v242
    v_cos_f32 v240, v243
    v_sin_f32 v241, v243
    s_nop 0
    v_cvt_pk_bf16_f32 v129, v240, v241
    v_cvt_pk_bf16_f32 v133, -v241, v240
    v_cvt_pk_bf16_f32 v137, v240, -v241
    v_cvt_pk_bf16_f32 v141, v241, v240
    v_add_f32 v242, v242, v244
    ds_read_b64_tr_b16 a[8:9], v11 offset:2048
    ds_read_b64_tr_b16 a[10:11], v11 offset:3072
    ds_read_b64_tr_b16 a[12:13], v11 offset:2304
    ds_read_b64_tr_b16 a[14:15], v11 offset:3328
    v_fract_f32 v243, v242
    v_cos_f32 v240, v243
    v_sin_f32 v241, v243
    s_nop 0
    v_cvt_pk_bf16_f32 v130, v240, v241
    v_cvt_pk_bf16_f32 v134, -v241, v240
    v_cvt_pk_bf16_f32 v138, v240, -v241
    v_cvt_pk_bf16_f32 v142, v241, v240
    v_add_f32 v242, v242, v244
    v_fract_f32 v243, v242
    v_cos_f32 v240, v243
    ds_read_b64_tr_b16 a[16:17], v11 offset:4096
    ds_read_b64_tr_b16 a[18:19], v11 offset:5120
    ds_read_b64_tr_b16 a[20:21], v11 offset:4352
    ds_read_b64_tr_b16 a[22:23], v11 offset:5376
    v_sin_f32 v241, v243
    s_nop 0
    v_cvt_pk_bf16_f32 v131, v240, v241
    v_cvt_pk_bf16_f32 v135, -v241, v240
    v_cvt_pk_bf16_f32 v139, v240, -v241
    v_cvt_pk_bf16_f32 v143, v241, v240
    s_lshl_b32 s73, s67, 4
    v_add_u32 v210, s73, v2
    v_cvt_f32_u32 v210, v210
    v_mul_f32 v210, 0x3a000000, v210
    ds_read_b64_tr_b16 a[24:25], v11 offset:6144
    ds_read_b64_tr_b16 a[26:27], v11 offset:7168
    ds_read_b64_tr_b16 a[28:29], v11 offset:6400
    ds_read_b64_tr_b16 a[30:31], v11 offset:7424
    v_lshlrev_b32 v211, 3, v3
    v_cvt_f32_u32 v211, v211
    v_mul_f32 v208, v211, v210
    v_fract_f32 v209, v208
    v_cos_f32 v144, v209
    v_sin_f32 v148, v209
    v_add_f32 v208, v208, v210
    v_fract_f32 v209, v208
    v_cos_f32 v152, v209
    s_waitcnt lgkmcnt(12)
    s_add_u32 m0, s100, 0
    s_add_u32 s74, s24, 65536
    buffer_load_dwordx4 v10, s[16:19], s74 offen lds
    v_sin_f32 v156, v209
    v_add_f32 v208, v208, v210
    v_fract_f32 v209, v208
    v_cos_f32 v145, v209
    v_sin_f32 v149, v209
    v_add_f32 v208, v208, v210
    v_fract_f32 v209, v208
    v_cos_f32 v153, v209
    v_sin_f32 v157, v209
    s_add_u32 m0, s100, 1024
    s_add_u32 s74, s24, 73728
    buffer_load_dwordx4 v10, s[16:19], s74 offen lds
    v_add_f32 v208, v208, v210
    v_fract_f32 v209, v208
    v_cos_f32 v146, v209
    v_sin_f32 v150, v209
    v_add_f32 v208, v208, v210
    v_fract_f32 v209, v208
    v_cos_f32 v154, v209
    v_sin_f32 v158, v209
    v_add_f32 v208, v208, v210
    v_fract_f32 v209, v208
    s_waitcnt lgkmcnt(8)
    s_add_u32 m0, s100, 2048
    s_add_u32 s74, s24, 81920
    buffer_load_dwordx4 v10, s[16:19], s74 offen lds
    v_cos_f32 v147, v209
    v_sin_f32 v151, v209
    v_add_f32 v208, v208, v210
    v_fract_f32 v209, v208
    v_cos_f32 v155, v209
    v_sin_f32 v159, v209
    v_mov_b32 v209, 0x35000000
    v_pk_mul_f32 v[144:145], v[144:145], v[208:209] op_sel:[0,1] op_sel_hi:[1,1]
    v_pk_mul_f32 v[146:147], v[146:147], v[208:209] op_sel:[0,1] op_sel_hi:[1,1]
    s_add_u32 m0, s100, 3072
    s_add_u32 s74, s24, 90112
    buffer_load_dwordx4 v10, s[16:19], s74 offen lds
    v_pk_mul_f32 v[148:149], v[148:149], v[208:209] op_sel:[0,1] op_sel_hi:[1,1]
    v_pk_mul_f32 v[150:151], v[150:151], v[208:209] op_sel:[0,1] op_sel_hi:[1,1]
    v_pk_mul_f32 v[152:153], v[152:153], v[208:209] op_sel:[0,1] op_sel_hi:[1,1]
    v_pk_mul_f32 v[154:155], v[154:155], v[208:209] op_sel:[0,1] op_sel_hi:[1,1]
    v_pk_mul_f32 v[156:157], v[156:157], v[208:209] op_sel:[0,1] op_sel_hi:[1,1]
    v_pk_mul_f32 v[158:159], v[158:159], v[208:209] op_sel:[0,1] op_sel_hi:[1,1]
    v_lshlrev_b32 v211, 2, v3
    v_add_u32 v211, s73, v211
    v_cvt_f32_u32 v211, v211
    s_waitcnt lgkmcnt(4)
    s_add_u32 m0, s100, 4096
    s_add_u32 s74, s24, 98304
    buffer_load_dwordx4 v10, s[16:19], s74 offen lds
    v_mul_f32 v211, 0x3a000000, v211
    v_lshlrev_b32 v210, 1, v2
    v_cvt_f32_u32 v210, v210
    v_mul_f32 v208, v211, v210
    v_fract_f32 v209, v208
    v_cos_f32 v160, v209
    v_sin_f32 v164, v209
    v_add_f32 v208, v208, v211
    v_fract_f32 v209, v208
    v_cos_f32 v168, v209
    s_add_u32 m0, s100, 5120
    s_add_u32 s74, s24, 106496
    buffer_load_dwordx4 v10, s[16:19], s74 offen lds
    v_sin_f32 v172, v209
    v_add_f32 v211, 0x3a000000, v211
    v_mul_f32 v208, v211, v210
    v_fract_f32 v209, v208
    v_cos_f32 v161, v209
    v_sin_f32 v165, v209
    v_add_f32 v208, v208, v211
    v_fract_f32 v209, v208
    v_cos_f32 v169, v209
    s_waitcnt lgkmcnt(0)
    s_add_u32 m0, s100, 6144
    s_add_u32 s74, s25, 0
    buffer_load_dwordx4 v10, s[16:19], s74 offen lds
    v_sin_f32 v173, v209
    v_add_f32 v211, 0x3a000000, v211
    v_mul_f32 v208, v211, v210
    v_fract_f32 v209, v208
    v_cos_f32 v162, v209
    v_sin_f32 v166, v209
    v_add_f32 v208, v208, v211
    v_fract_f32 v209, v208
    v_cos_f32 v170, v209
    s_add_u32 m0, s100, 7168
    s_add_u32 s74, s25, 8192
    buffer_load_dwordx4 v10, s[16:19], s74 offen lds
    v_sin_f32 v174, v209
    v_add_f32 v211, 0x3a000000, v211
    v_mul_f32 v208, v211, v210
    v_fract_f32 v209, v208
    v_cos_f32 v163, v209
    v_sin_f32 v167, v209
    v_add_f32 v208, v208, v211
    v_fract_f32 v209, v208
    v_cos_f32 v171, v209
    v_sin_f32 v175, v209
    v_lshrrev_b32 v12, 2, v2
    v_lshlrev_b32 v14, 7, v12
    v_and_b32 v12, 3, v2
    v_lshl_add_u32 v14, v12, 4, v14
    v_lshl_add_u32 v14, v3, 9, v14
    s_lshr_b32 s56, s66, 1
    s_lshl_b32 s56, s56, 15
    s_and_b32 s73, s66, 1
    s_lshl_b32 s73, s73, 6
    s_add_u32 s56, s56, s73
    s_lshl_b32 s73, s67, 13
    s_add_u32 s56, s56, s73
    s_add_u32 s56, s56, 4194304
    s_add_u32 s55, s56, 4096
    v_lshrrev_b32 v12, 5, v1
    v_lshlrev_b32 v12, 12, v12
    v_and_b32 v13, 31, v1
    v_lshl_add_u32 v12, v13, 4, v12
    s_lshl_b32 s73, s67, 10
    s_add_u32 s75, s73, 147456
    v_add_u32 v6, s75, v12
    v_add_u32 v15, 155648, v5
    v_add_u32 v9, 147456, v5
    s_lshl_b32 s75, s66, 3
    s_add_u32 s75, s75, 23101440
    v_mov_b32 v13, s75
    v_cmp_eq_u32 vcc, 0, v0
    s_nop 1
    v_cndmask_b32 v79, v79, v13, vcc
    s_waitcnt vmcnt(12)
    v_max3_u32 v12, v192, v193, v194
    v_max3_u32 v12, v12, v195, v196
    v_max3_u32 v12, v12, v197, v198
    v_max3_u32 v12, v12, v199, v199
    v_cmp_eq_u32 vcc, -1, v12
    s_cbranch_vccnz L_retry_3
L_cont_4:
    ds_write_b128 v6, v[192:195]
    ds_write_b128 v6, v[196:199] offset:512
    buffer_load_dwordx4 v[240:243], v14, s[8:11], s56 offen offset:0 sc1
    buffer_load_dwordx4 v[244:247], v14, s[8:11], s56 offen offset:2048 sc1
    buffer_load_dwordx4 v[248:251], v14, s[8:11], s55 offen offset:0 sc1
    buffer_load_dwordx4 v[252:255], v14, s[8:11], s55 offen offset:2048 sc1
    s_waitcnt vmcnt(14) lgkmcnt(0)
    s_barrier
    ds_read_b128 v[192:195], v9 offset:0
    ds_read_b128 v[208:211], v9 offset:4096
    ds_read_b128 v[196:199], v9 offset:1024
    ds_read_b128 v[212:215], v9 offset:5120
    ds_read_b128 v[200:203], v9 offset:2048
    ds_read_b128 v[216:219], v9 offset:6144
    ds_read_b128 v[204:207], v9 offset:3072
    ds_read_b128 v[220:223], v9 offset:7168
    v_add_u32 v6, s73, v15
    v_mov_b32 v12, s68
    buffer_store_dword v12, v79, s[8:11], 0 offen sc1
    s_waitcnt lgkmcnt(6)
    v_mfma_f32_16x16x32_bf16 v[224:227], v[192:195], v[80:83], 0
    v_mfma_f32_16x16x32_bf16 v[228:231], v[192:195], v[84:87], 0
    v_mfma_f32_16x16x32_bf16 v[232:235], v[208:211], v[88:91], 0
    v_mfma_f32_16x16x32_bf16 v[236:239], v[208:211], v[92:95], 0
    s_waitcnt lgkmcnt(4)
    v_mfma_f32_16x16x32_bf16 v[224:227], v[196:199], v[96:99], v[224:227]
    buffer_store_dwordx4 a[224:227], v5, s[8:11], s52 offen offset:0 sc1
    v_mfma_f32_16x16x32_bf16 v[228:231], v[196:199], v[100:103], v[228:231]
    v_mfma_f32_16x16x32_bf16 v[232:235], v[212:215], v[104:107], v[232:235]
    v_mfma_f32_16x16x32_bf16 v[236:239], v[212:215], v[108:111], v[236:239]
    s_waitcnt lgkmcnt(2)
    v_mfma_f32_16x16x32_bf16 v[224:227], v[200:203], v[112:115], v[224:227]
    v_mfma_f32_16x16x32_bf16 v[228:231], v[200:203], v[116:119], v[228:231]
    buffer_store_dwordx4 a[224:227], v5, s[8:11], s52 offen offset:1024 sc1
    v_mfma_f32_16x16x32_bf16 v[232:235], v[216:219], v[120:123], v[232:235]
    v_mfma_f32_16x16x32_bf16 v[236:239], v[216:219], v[124:127], v[236:239]
    s_waitcnt lgkmcnt(0)
    v_mfma_f32_16x16x32_bf16 v[224:227], v[204:207], v[128:131], v[224:227]
    v_mfma_f32_16x16x32_bf16 v[228:231], v[204:207], v[132:135], v[228:231]
    v_mfma_f32_16x16x32_bf16 v[232:235], v[220:223], v[136:139], v[232:235]
    v_mfma_f32_16x16x32_bf16 v[236:239], v[220:223], v[140:143], v[236:239]
    s_nop 6
    v_pk_add_f32 v[192:193], v[224:225], v[232:233]
    v_pk_add_f32 v[196:197], v[228:229], v[236:237] neg_lo:[0,1] neg_hi:[0,1]
    v_pk_add_f32 v[200:201], v[228:229], v[236:237]
    v_pk_add_f32 v[204:205], v[232:233], v[224:225] neg_lo:[0,1] neg_hi:[0,1]
    v_pk_add_f32 v[194:195], v[226:227], v[234:235]
    v_pk_add_f32 v[198:199], v[230:231], v[238:239] neg_lo:[0,1] neg_hi:[0,1]
    v_pk_add_f32 v[202:203], v[230:231], v[238:239]
    v_pk_add_f32 v[206:207], v[234:235], v[226:227] neg_lo:[0,1] neg_hi:[0,1]
    v_pk_mul_f32 v[208:209], v[196:197], v[148:149]
    v_pk_mul_f32 v[210:211], v[192:193], v[148:149]
    v_pk_fma_f32 v[224:225], v[192:193], v[144:145], v[208:209]
    v_pk_fma_f32 v[228:229], v[196:197], v[144:145], v[210:211] neg_lo:[0,0,1] neg_hi:[0,0,1]
    v_pk_mul_f32 v[212:213], v[204:205], v[156:157]
    v_pk_mul_f32 v[214:215], v[200:201], v[156:157]
    v_pk_fma_f32 v[232:233], v[200:201], v[152:153], v[212:213]
    v_pk_fma_f32 v[236:237], v[204:205], v[152:153], v[214:215] neg_lo:[0,0,1] neg_hi:[0,0,1]
    v_pk_mul_f32 v[208:209], v[198:199], v[150:151]
    v_pk_mul_f32 v[210:211], v[194:195], v[150:151]
    v_pk_fma_f32 v[226:227], v[194:195], v[146:147], v[208:209]
    v_pk_fma_f32 v[230:231], v[198:199], v[146:147], v[210:211] neg_lo:[0,0,1] neg_hi:[0,0,1]
    v_pk_mul_f32 v[212:213], v[206:207], v[158:159]
    v_pk_mul_f32 v[214:215], v[202:203], v[158:159]
    v_pk_fma_f32 v[234:235], v[202:203], v[154:155], v[212:213]
    v_pk_fma_f32 v[238:239], v[206:207], v[154:155], v[214:215] neg_lo:[0,0,1] neg_hi:[0,0,1]
    v_cvt_pk_bf16_f32 v216, v224, v225
    s_add_u32 m0, s29, 0
    s_nop 0
    buffer_load_dwordx4 v72, s[12:15], s63 offen lds
    v_cvt_pk_bf16_f32 v217, v226, v227
    v_cvt_pk_bf16_f32 v218, v228, v229
    v_cvt_pk_bf16_f32 v219, v230, v231
    v_cvt_pk_bf16_f32 v220, v232, v233
    v_cvt_pk_bf16_f32 v221, v234, v235
    v_cvt_pk_bf16_f32 v222, v236, v237
    v_cvt_pk_bf16_f32 v223, v238, v239
    v_mfma_f32_16x16x32_bf16 v[224:227], v[18:21], v[216:219], 0
    v_mfma_f32_16x16x32_bf16 v[228:231], v[16:19], v[216:219], 0
    v_mfma_f32_16x16x32_bf16 v[232:235], v[38:41], v[216:219], 0
    v_mfma_f32_16x16x32_bf16 v[236:239], v[36:39], v[216:219], 0
    v_mfma_f32_16x16x32_bf16 v[224:227], v[28:31], v[220:223], v[224:227]
    v_mfma_f32_16x16x32_bf16 v[228:231], v[26:29], v[220:223], v[228:231]
    v_mfma_f32_16x16x32_bf16 v[232:235], v[48:51], v[220:223], v[232:235]
    v_mfma_f32_16x16x32_bf16 v[236:239], v[46:49], v[220:223], v[236:239]
    s_waitcnt vmcnt(4)
    v_cmp_ne_u64 vcc, s[46:47], v[242:243]
    v_cmp_ne_u64 s[40:41], s[46:47], v[246:247]
    v_cmp_ne_u64 s[42:43], s[46:47], v[250:251]
    v_cmp_ne_u64 s[44:45], s[46:47], v[254:255]
    s_or_b64 vcc, vcc, s[40:41]
    s_or_b64 vcc, vcc, s[42:43]
    s_or_b64 vcc, vcc, s[44:45]
    s_cbranch_vccnz L_retry_5
L_cont_6:
    v_lshlrev_b32 v176, 16, v240
    v_lshlrev_b32 v184, 16, v244
    v_lshlrev_b32 v177, 16, v241
    v_lshlrev_b32 v185, 16, v245
    v_lshlrev_b32 v178, 16, v248
    v_lshlrev_b32 v186, 16, v252
    v_lshlrev_b32 v179, 16, v249
    v_lshlrev_b32 v187, 16, v253
    v_and_b32 v180, s78, v240
    v_and_b32 v188, s78, v244
    v_and_b32 v181, s78, v241
    v_and_b32 v189, s78, v245
    v_and_b32 v182, s78, v248
    v_and_b32 v190, s78, v252
    v_and_b32 v183, s78, v249
    v_and_b32 v191, s78, v253
    v_pk_mul_f32 v[208:209], v[228:229], v[184:185]
    v_pk_mul_f32 v[210:211], v[224:225], v[184:185]
    v_pk_fma_f32 v[192:193], v[224:225], v[176:177], v[208:209] neg_lo:[0,0,1] neg_hi:[0,0,1]
    v_pk_fma_f32 v[196:197], v[228:229], v[176:177], v[210:211]
    v_pk_mul_f32 v[208:209], v[230:231], v[186:187]
    v_pk_mul_f32 v[210:211], v[226:227], v[186:187]
    v_pk_fma_f32 v[194:195], v[226:227], v[178:179], v[208:209] neg_lo:[0,0,1] neg_hi:[0,0,1]
    s_add_u32 m0, s29, 1024
    s_nop 0
    buffer_load_dwordx4 v73, s[12:15], s63 offen lds
    v_pk_fma_f32 v[198:199], v[230:231], v[178:179], v[210:211]
    v_pk_mul_f32 v[212:213], v[236:237], v[188:189]
    v_pk_mul_f32 v[214:215], v[232:233], v[188:189]
    v_pk_fma_f32 v[200:201], v[232:233], v[180:181], v[212:213] neg_lo:[0,0,1] neg_hi:[0,0,1]
    v_pk_fma_f32 v[204:205], v[236:237], v[180:181], v[214:215]
    v_pk_mul_f32 v[212:213], v[238:239], v[190:191]
    v_pk_mul_f32 v[214:215], v[234:235], v[190:191]
    v_pk_fma_f32 v[202:203], v[234:235], v[182:183], v[212:213] neg_lo:[0,0,1] neg_hi:[0,0,1]
    v_pk_fma_f32 v[206:207], v[238:239], v[182:183], v[214:215]
    v_cvt_pk_bf16_f32 v216, v192, v193
    v_cvt_pk_bf16_f32 v217, v194, v195
    v_cvt_pk_bf16_f32 v218, v196, v197
    v_cvt_pk_bf16_f32 v219, v198, v199
    v_cvt_pk_bf16_f32 v220, v200, v201
    v_cvt_pk_bf16_f32 v221, v202, v203
    v_cvt_pk_bf16_f32 v222, v204, v205
    v_cvt_pk_bf16_f32 v223, v206, v207
    v_mfma_f32_16x16x32_bf16 v[224:227], v[216:219], v[22:25], 0
    s_add_u32 m0, s28, 2048
    s_nop 0
    buffer_load_dwordx4 v74, s[12:15], s62 offen lds
    v_mfma_f32_16x16x32_bf16 v[228:231], v[216:219], v[20:23], 0
    s_add_u32 m0, s28, 3072
    s_nop 0
    buffer_load_dwordx4 v75, s[12:15], s62 offen lds
    v_mfma_f32_16x16x32_bf16 v[232:235], v[216:219], v[42:45], 0
    v_mfma_f32_16x16x32_bf16 v[236:239], v[216:219], v[40:43], 0
    s_add_u32 m0, s28, 4096
    s_nop 0
    buffer_load_dwordx4 v76, s[12:15], s62 offen lds
    v_mfma_f32_16x16x32_bf16 v[224:227], v[220:223], v[32:35], v[224:227]
    s_add_u32 m0, s28, 5120
    s_nop 0
    buffer_load_dwordx4 v77, s[12:15], s62 offen lds
    v_mfma_f32_16x16x32_bf16 v[228:231], v[220:223], v[30:33], v[228:231]
    s_add_u32 m0, s28, 6144
    s_nop 0
    buffer_load_dwordx4 v78, s[12:15], s62 offen lds
    v_mfma_f32_16x16x32_bf16 v[232:235], v[220:223], v[52:55], v[232:235]
    v_mfma_f32_16x16x32_bf16 v[236:239], v[220:223], v[50:53], v[236:239]
    s_nop 2
    v_pk_mul_f32 v[208:209], v[228:229], v[164:165]
    v_pk_mul_f32 v[210:211], v[224:225], v[164:165]
    v_pk_fma_f32 v[192:193], v[224:225], v[160:161], v[208:209] neg_lo:[0,0,1] neg_hi:[0,0,1]
    v_pk_fma_f32 v[196:197], v[228:229], v[160:161], v[210:211]
    v_pk_mul_f32 v[208:209], v[230:231], v[166:167]
    v_pk_mul_f32 v[210:211], v[226:227], v[166:167]
    v_pk_fma_f32 v[194:195], v[226:227], v[162:163], v[208:209] neg_lo:[0,0,1] neg_hi:[0,0,1]
    v_pk_fma_f32 v[198:199], v[230:231], v[162:163], v[210:211]
    v_pk_mul_f32 v[212:213], v[236:237], v[172:173]
    v_pk_mul_f32 v[214:215], v[232:233], v[172:173]
    v_pk_fma_f32 v[200:201], v[232:233], v[168:169], v[212:213] neg_lo:[0,0,1] neg_hi:[0,0,1]
    v_pk_fma_f32 v[204:205], v[236:237], v[168:169], v[214:215]
    v_pk_mul_f32 v[212:213], v[238:239], v[174:175]
    v_pk_mul_f32 v[214:215], v[234:235], v[174:175]
    v_pk_fma_f32 v[202:203], v[234:235], v[170:171], v[212:213] neg_lo:[0,0,1] neg_hi:[0,0,1]
    v_pk_fma_f32 v[206:207], v[238:239], v[170:171], v[214:215]
    v_pk_add_f32 v[224:225], v[192:193], v[204:205] neg_lo:[0,1] neg_hi:[0,1]
    s_add_u32 m0, s29, 2048
    s_nop 0
    buffer_load_dwordx4 v74, s[12:15], s63 offen lds
    v_pk_add_f32 v[228:229], v[196:197], v[200:201]
    v_pk_add_f32 v[226:227], v[194:195], v[206:207] neg_lo:[0,1] neg_hi:[0,1]
    v_pk_add_f32 v[230:231], v[198:199], v[202:203]
    v_cvt_pk_bf16_f32 v216, v224, v228
    v_cvt_pk_bf16_f32 v217, v225, v229
    v_cvt_pk_bf16_f32 v218, v226, v230
    v_cvt_pk_bf16_f32 v219, v227, v231
    ds_write_b128 v6, v[216:219]
    v_pk_add_f32 v[232:233], v[192:193], v[204:205]
    v_pk_add_f32 v[236:237], v[200:201], v[196:197] neg_lo:[0,1] neg_hi:[0,1]
    v_pk_add_f32 v[234:235], v[194:195], v[206:207]
    v_pk_add_f32 v[238:239], v[202:203], v[198:199] neg_lo:[0,1] neg_hi:[0,1]
    v_cvt_pk_bf16_f32 v220, v232, v236
    v_cvt_pk_bf16_f32 v221, v233, v237
    v_cvt_pk_bf16_f32 v222, v234, v238
    v_cvt_pk_bf16_f32 v223, v235, v239
    ds_write_b128 v6, v[220:223] offset:4096
    s_waitcnt lgkmcnt(0)
    s_barrier
    s_lshl_b32 s72, s67, 9
    s_add_u32 s72, s72, 23101440
    v_lshlrev_b32 v145, 3, v1
    ds_read_b128 v[192:195], v15 offset:0
    ds_read_b128 v[208:211], v15 offset:4096
    ds_read_b128 v[196:199], v15 offset:1024
    ds_read_b128 v[212:215], v15 offset:5120
    ds_read_b128 v[200:203], v15 offset:2048
    ds_read_b128 v[216:219], v15 offset:6144
    ds_read_b128 v[204:207], v15 offset:3072
    ds_read_b128 v[220:223], v15 offset:7168
    s_waitcnt lgkmcnt(6)
    v_mfma_f32_16x16x32_bf16 v[224:227], v[88:91], v[192:195], 0
    v_mfma_f32_16x16x32_bf16 v[228:231], v[92:95], v[192:195], 0
    v_mfma_f32_16x16x32_bf16 v[232:235], v[80:83], v[208:211], 0
    v_mfma_f32_16x16x32_bf16 v[236:239], v[84:87], v[208:211], 0
    s_waitcnt lgkmcnt(4)
    v_mfma_f32_16x16x32_bf16 v[224:227], v[104:107], v[196:199], v[224:227]
    v_mov_b32 v12, 0x7ffffff0
    v_mov_b32 v13, 0x1610000
    s_cmp_eq_u32 s2, 0
    s_cselect_b32 s53, 0, -1
    v_cmp_eq_u32 vcc, s53, v0
    s_nop 1
    v_cndmask_b32 v12, v12, v13, vcc
    v_mov_b32 v13, s59
    buffer_store_dword v13, v12, s[8:11], 0 offen
    v_mfma_f32_16x16x32_bf16 v[228:231], v[108:111], v[196:199], v[228:231]
    v_mfma_f32_16x16x32_bf16 v[232:235], v[96:99], v[212:215], v[232:235]
    v_mfma_f32_16x16x32_bf16 v[236:239], v[100:103], v[212:215], v[236:239]
    s_waitcnt lgkmcnt(2)
    v_mfma_f32_16x16x32_bf16 v[224:227], v[120:123], v[200:203], v[224:227]
    v_mfma_f32_16x16x32_bf16 v[228:231], v[124:127], v[200:203], v[228:231]
    buffer_store_dwordx4 a[224:227], v5, s[8:11], s52 offen offset:2048 sc1
    v_mfma_f32_16x16x32_bf16 v[232:235], v[112:115], v[216:219], v[232:235]
    v_mfma_f32_16x16x32_bf16 v[236:239], v[116:119], v[216:219], v[236:239]
    s_waitcnt lgkmcnt(0)
    v_mfma_f32_16x16x32_bf16 v[224:227], v[136:139], v[204:207], v[224:227]
    v_mfma_f32_16x16x32_bf16 v[228:231], v[140:143], v[204:207], v[228:231]
    v_mfma_f32_16x16x32_bf16 v[232:235], v[128:131], v[220:223], v[232:235]
    v_mfma_f32_16x16x32_bf16 v[236:239], v[132:135], v[220:223], v[236:239]
    s_nop 7
    s_cmp_lg_u32 s66, 255
    s_cbranch_scc1 L_nonyq_7
    v_add_f32 v224, v224, v232
    v_mul_f32 v224, 0.5, v224
    v_mov_b32 v232, 0
    v_add_f32 v225, v225, v233
    v_mul_f32 v225, 0.5, v225
    v_mov_b32 v233, 0
    v_add_f32 v226, v226, v234
    v_mul_f32 v226, 0.5, v226
    v_mov_b32 v234, 0
    v_add_f32 v227, v227, v235
    v_mul_f32 v227, 0.5, v227
    v_mov_b32 v235, 0
    v_add_f32 v228, v228, v236
    v_mul_f32 v228, 0.5, v228
    v_mov_b32 v236, 0
    v_add_f32 v229, v229, v237
    v_mul_f32 v229, 0.5, v229
    v_mov_b32 v237, 0
    v_add_f32 v230, v230, v238
    v_mul_f32 v230, 0.5, v230
    v_mov_b32 v238, 0
    v_add_f32 v231, v231, v239
    v_mul_f32 v231, 0.5, v231
    v_mov_b32 v239, 0
L_nonyq_7:
    v_cvt_pk_bf16_f32 v192, v224, v228
    v_cvt_pk_bf16_f32 v196, v232, v236
    v_cvt_pk_bf16_f32 v193, v225, v229
    v_cvt_pk_bf16_f32 v197, v233, v237
    v_cvt_pk_bf16_f32 v194, v226, v230
    v_cvt_pk_bf16_f32 v198, v234, v238
    v_cvt_pk_bf16_f32 v195, v227, v231
    v_cvt_pk_bf16_f32 v199, v235, v239
    buffer_load_dword v144, v145, s[8:11], s72 offen sc1
    v_permlane32_swap_b32 v192, v196
    v_permlane32_swap_b32 v193, v197
    v_permlane32_swap_b32 v194, v198
    v_permlane32_swap_b32 v195, v199
    buffer_store_dwordx4 v[192:195], v8, s[8:11], s49 offen sc1
    buffer_store_dwordx4 v[196:199], v8, s[8:11], s49 offen offset:1024 sc1
    v_mov_b32 v9, v7
    v_lshlrev_b32 v14, 6, v2
    v_and_b32 v13, 1, v3
    v_lshl_add_u32 v14, v13, 5, v14
    v_lshrrev_b32 v13, 1, v3
    v_lshl_add_u32 v14, v13, 4, v14
    buffer_load_dwordx4 v[160:163], v14, s[4:7], s76 offen offset:0
    buffer_load_dwordx4 v[164:167], v14, s[4:7], s76 offen offset:1024
    v_cvt_f32_u32 v210, v2
    v_mul_f32 v210, 0x3d800000, v210
    v_lshlrev_b32 v208, 2, v3
    ds_read_b64_tr_b16 a[32:33], v11 offset:0
    ds_read_b64_tr_b16 a[34:35], v11 offset:1024
    ds_read_b64_tr_b16 a[36:37], v11 offset:256
    ds_read_b64_tr_b16 a[38:39], v11 offset:1280
    v_cvt_f32_u32 v208, v208
    v_mul_f32 v208, v208, v210
    v_fract_f32 v209, v208
    ds_read_b64_tr_b16 a[40:41], v11 offset:2048
    ds_read_b64_tr_b16 a[42:43], v11 offset:3072
    ds_read_b64_tr_b16 a[44:45], v11 offset:2304
    ds_read_b64_tr_b16 a[46:47], v11 offset:3328
    v_cos_f32 v200, v209
    v_sin_f32 v204, v209
    v_add_f32 v208, v208, v210
    ds_read_b64_tr_b16 a[48:49], v11 offset:4096
    ds_read_b64_tr_b16 a[50:51], v11 offset:5120
    ds_read_b64_tr_b16 a[52:53], v11 offset:4352
    ds_read_b64_tr_b16 a[54:55], v11 offset:5376
    v_fract_f32 v209, v208
    v_cos_f32 v201, v209
    v_sin_f32 v205, v209
    ds_read_b64_tr_b16 a[56:57], v11 offset:6144
    ds_read_b64_tr_b16 a[58:59], v11 offset:7168
    ds_read_b64_tr_b16 a[60:61], v11 offset:6400
    ds_read_b64_tr_b16 a[62:63], v11 offset:7424
    v_add_f32 v208, v208, v210
    v_fract_f32 v209, v208
    v_cos_f32 v202, v209
    s_waitcnt lgkmcnt(12)
    s_add_u32 m0, s100, 0
    s_add_u32 s74, s25, 16384
    buffer_load_dwordx4 v10, s[16:19], s74 offen lds
    v_sin_f32 v206, v209
    v_add_f32 v208, v208, v210
    v_fract_f32 v209, v208
    s_add_u32 m0, s100, 1024
    s_add_u32 s74, s25, 24576
    buffer_load_dwordx4 v10, s[16:19], s74 offen lds
    v_cos_f32 v203, v209
    v_sin_f32 v207, v209
    v_cvt_pk_bf16_f32 v80, v200, -v204
    s_waitcnt lgkmcnt(8)
    s_add_u32 m0, s100, 2048
    s_add_u32 s74, s25, 32768
    buffer_load_dwordx4 v10, s[16:19], s74 offen lds
    v_cvt_pk_bf16_f32 v84, v204, v200
    v_cvt_pk_bf16_f32 v81, v201, -v205
    v_cvt_pk_bf16_f32 v85, v205, v201
    s_add_u32 m0, s100, 3072
    s_add_u32 s74, s25, 40960
    buffer_load_dwordx4 v10, s[16:19], s74 offen lds
    v_cvt_pk_bf16_f32 v82, v202, -v206
    v_cvt_pk_bf16_f32 v86, v206, v202
    v_cvt_pk_bf16_f32 v83, v203, -v207
    s_waitcnt lgkmcnt(4)
    s_add_u32 m0, s100, 4096
    s_add_u32 s74, s25, 49152
    buffer_load_dwordx4 v10, s[16:19], s74 offen lds
    v_cvt_pk_bf16_f32 v87, v207, v203
    s_lshl_b32 s70, s67, 5
    s_add_u32 s70, s70, 0
    s_add_u32 m0, s100, 5120
    s_add_u32 s74, s25, 57344
    buffer_load_dwordx4 v10, s[16:19], s74 offen lds
    v_and_b32 v12, 31, v1
    v_add_u32 v12, s70, v12
    v_sub_u32 v13, 511, v12
    s_waitcnt lgkmcnt(0)
    s_add_u32 m0, s100, 6144
    s_add_u32 s74, s25, 65536
    buffer_load_dwordx4 v10, s[16:19], s74 offen lds
    v_cmp_eq_u32 vcc, 255, v12
    v_add_u32 v12, 1, v12
    s_nop 0
    v_cndmask_b32 v13, v13, 0, vcc
    s_add_u32 m0, s100, 7168
    s_add_u32 s74, s25, 73728
    buffer_load_dwordx4 v10, s[16:19], s74 offen lds
    v_cmp_le_u32 vcc, 32, v1
    v_mov_b32 v6, 147456
    s_nop 0
    v_cndmask_b32 v12, v12, v13, vcc
    buffer_store_dwordx4 a[224:227], v5, s[8:11], s52 offen offset:3072 sc1
    v_and_b32 v13, 1, v12
    v_lshl_add_u32 v6, v13, 10, v6
    v_lshrrev_b32 v13, 7, v12
    buffer_store_dwordx4 a[224:227], v5, s[8:11], s58 offen offset:0 sc1
    v_lshl_add_u32 v6, v13, 8, v6
    v_bfe_u32 v13, v12, 1, 4
    v_lshl_add_u32 v6, v13, 4, v6
    s_add_u32 m0, s29, 3072
    s_nop 0
    buffer_load_dwordx4 v75, s[12:15], s63 offen lds
    v_bfe_u32 v13, v12, 5, 2
    v_lshl_add_u32 v6, v13, 2, v6
    s_lshl_b32 s70, s67, 5
    s_add_u32 m0, s29, 4096
    s_nop 0
    buffer_load_dwordx4 v76, s[12:15], s63 offen lds
    s_add_u32 s70, s70, 128
    v_and_b32 v12, 31, v1
    v_add_u32 v12, s70, v12
    s_add_u32 m0, s29, 5120
    s_nop 0
    buffer_load_dwordx4 v77, s[12:15], s63 offen lds
    v_sub_u32 v13, 511, v12
    v_cmp_eq_u32 vcc, 255, v12
    v_add_u32 v12, 1, v12
    s_add_u32 m0, s29, 6144
    s_nop 0
    buffer_load_dwordx4 v78, s[12:15], s63 offen lds
    v_cndmask_b32 v13, v13, 0, vcc
    v_cmp_le_u32 vcc, 32, v1
    v_mov_b32 v7, 147456
    s_add_u32 m0, s30, 0
    s_nop 0
    buffer_load_dwordx4 v72, s[12:15], s80 offen lds
    v_cndmask_b32 v12, v12, v13, vcc
    v_and_b32 v13, 1, v12
    v_lshl_add_u32 v7, v13, 10, v7
    s_add_u32 m0, s30, 1024
    s_nop 0
    buffer_load_dwordx4 v73, s[12:15], s80 offen lds
    v_lshrrev_b32 v13, 7, v12
    v_lshl_add_u32 v7, v13, 8, v7
    v_bfe_u32 v13, v12, 1, 4
    s_add_u32 m0, s30, 2048
    s_nop 0
    buffer_load_dwordx4 v74, s[12:15], s80 offen lds
    v_lshl_add_u32 v7, v13, 4, v7
    v_bfe_u32 v13, v12, 5, 2
    v_lshl_add_u32 v7, v13, 2, v7
    s_add_u32 m0, s30, 3072
    s_nop 0
    buffer_load_dwordx4 v75, s[12:15], s80 offen lds
    s_lshl_b32 s70, s67, 18
    s_lshl_b32 s71, s64, 9
    s_add_u32 s70, s70, s71
    s_add_u32 m0, s30, 4096
    s_nop 0
    buffer_load_dwordx4 v76, s[12:15], s80 offen lds
    s_lshl_b32 s71, s65, 5
    s_add_u32 s70, s70, s71
    s_add_u32 s70, s70, 8388608
    s_add_u32 s71, s70, 1048576
    s_waitcnt vmcnt(23)
    v_cmp_ne_u32 vcc, s68, v144
    s_cbranch_vccnz L_retry_8
L_cont_9:
    s_barrier
    s_waitcnt vmcnt(19)
    buffer_load_dwordx4 v[104:107], v4, s[8:11], s70 offen sc1
    buffer_load_dwordx4 v[108:111], v4, s[8:11], s71 offen sc1
    v_permlane16_swap_b32 v160, v162
    buffer_store_dwordx4 a[224:227], v5, s[8:11], s58 offen offset:1024 sc1
    v_permlane16_swap_b32 v161, v163
    buffer_store_dwordx4 a[224:227], v5, s[8:11], s58 offen offset:2048 sc1
    v_permlane16_swap_b32 v164, v166
    v_permlane16_swap_b32 v165, v167
    s_mul_i32 s53, s65, 224
    buffer_load_dwordx4 v[212:215], v5, s[32:35], s53 offen
    v_lshlrev_b32 v88, 16, v160
    s_waitcnt vmcnt(22)
    ds_read_b64_tr_b16 a[64:65], v11 offset:0
    ds_read_b64_tr_b16 a[66:67], v11 offset:1024
    ds_read_b64_tr_b16 a[68:69], v11 offset:256
    ds_read_b64_tr_b16 a[70:71], v11 offset:1280
    v_and_b32 v89, s78, v160
    v_lshlrev_b32 v90, 16, v161
    s_waitcnt vmcnt(20)
    ds_read_b64_tr_b16 a[72:73], v11 offset:2048
    ds_read_b64_tr_b16 a[74:75], v11 offset:3072
    ds_read_b64_tr_b16 a[76:77], v11 offset:2304
    ds_read_b64_tr_b16 a[78:79], v11 offset:3328
    v_and_b32 v91, s78, v161
    s_waitcnt vmcnt(18)
    ds_read_b64_tr_b16 a[80:81], v11 offset:4096
    ds_read_b64_tr_b16 a[82:83], v11 offset:5120
    ds_read_b64_tr_b16 a[84:85], v11 offset:4352
    ds_read_b64_tr_b16 a[86:87], v11 offset:5376
    v_lshlrev_b32 v92, 16, v162
    v_and_b32 v93, s78, v162
    s_waitcnt vmcnt(16)
    ds_read_b64_tr_b16 a[88:89], v11 offset:6144
    ds_read_b64_tr_b16 a[90:91], v11 offset:7168
    ds_read_b64_tr_b16 a[92:93], v11 offset:6400
    ds_read_b64_tr_b16 a[94:95], v11 offset:7424
    v_lshlrev_b32 v94, 16, v163
    s_waitcnt lgkmcnt(12)
    s_add_u32 m0, s100, 0
    s_add_u32 s74, s25, 81920
    buffer_load_dwordx4 v10, s[16:19], s74 offen lds
    v_and_b32 v95, s78, v163
    s_add_u32 m0, s100, 1024
    s_add_u32 s74, s25, 90112
    buffer_load_dwordx4 v10, s[16:19], s74 offen lds
    v_lshlrev_b32 v96, 16, v164
    v_and_b32 v97, s78, v164
    s_waitcnt lgkmcnt(8)
    s_add_u32 m0, s100, 2048
    s_add_u32 s74, s25, 98304
    buffer_load_dwordx4 v10, s[16:19], s74 offen lds
    v_lshlrev_b32 v98, 16, v165
    s_add_u32 m0, s100, 3072
    s_add_u32 s74, s25, 106496
    buffer_load_dwordx4 v10, s[16:19], s74 offen lds
    v_and_b32 v99, s78, v165
    v_lshlrev_b32 v100, 16, v166
    s_waitcnt lgkmcnt(4)
    s_add_u32 m0, s100, 4096
    s_add_u32 s74, s26, 0
    buffer_load_dwordx4 v10, s[16:19], s74 offen lds
    v_and_b32 v101, s78, v166
    s_add_u32 m0, s100, 5120
    s_add_u32 s74, s26, 8192
    buffer_load_dwordx4 v10, s[16:19], s74 offen lds
    v_lshlrev_b32 v102, 16, v167
    v_and_b32 v103, s78, v167
    s_waitcnt lgkmcnt(0)
    s_add_u32 m0, s100, 6144
    s_add_u32 s74, s26, 16384
    buffer_load_dwordx4 v10, s[16:19], s74 offen lds
    s_lshl_b32 s72, s67, 11
    s_add_u32 m0, s100, 7168
    s_add_u32 s74, s26, 24576
    buffer_load_dwordx4 v10, s[16:19], s74 offen lds
    s_add_u32 s72, s72, 147456
    v_add_u32 v14, s72, v5
    s_waitcnt vmcnt(11)
    v_max3_u32 v12, v104, v105, v106
    v_max3_u32 v12, v12, v107, v108
    v_max3_u32 v12, v12, v109, v110
    v_max3_u32 v12, v12, v111, v111
    v_cmp_eq_u32 vcc, -1, v12
    s_cbranch_vccnz L_retry_10
L_cont_11:
    ds_write_b32 v6, v104 offset:0
    ds_write_b32 v6, v105 offset:2048
    ds_write_b32 v6, v106 offset:4096
    ds_write_b32 v6, v107 offset:6144
    ds_write_b32 v7, v108 offset:0
    ds_write_b32 v7, v109 offset:2048
    ds_write_b32 v7, v110 offset:4096
    ds_write_b32 v7, v111 offset:6144
    s_waitcnt lgkmcnt(0)
    s_barrier
    ds_read_b128 v[104:107], v14
    ds_read_b128 v[108:111], v14 offset:1024
    v_lshlrev_b32 v12, 2, v2
    v_add_u32 v12, v12, v3
    v_lshlrev_b32 v12, 7, v12
    s_lshl_b32 s70, s67, 1
    v_and_b32 v13, 7, v2
    v_xor_b32 v13, s70, v13
    v_lshl_add_u32 v6, v13, 4, v12
    v_add_u32 v6, 155648, v6
    v_xor_b32 v7, 16, v6
    s_add_u32 m0, s30, 5120
    s_nop 0
    buffer_load_dwordx4 v77, s[12:15], s80 offen lds
    s_waitcnt lgkmcnt(1)
    v_mfma_f32_16x16x32_bf16 v[112:115], v[104:107], v[80:83], 0
    v_mfma_f32_16x16x32_bf16 v[120:123], v[104:107], v[84:87], 0
    s_waitcnt lgkmcnt(0)
    v_mfma_f32_16x16x32_bf16 v[116:119], v[108:111], v[80:83], 0
    v_mfma_f32_16x16x32_bf16 v[124:127], v[108:111], v[84:87], 0
    v_lshrrev_b32 v12, 5, v0
    v_xor_b32 v12, v12, v0
    v_and_b32 v12, 7, v12
    v_lshrrev_b32 v13, 3, v0
    v_lshlrev_b32 v13, 7, v13
    v_lshl_add_u32 v15, v12, 4, v13
    v_add_u32 v15, 155648, v15
    s_add_u32 m0, s30, 6144
    s_nop 0
    buffer_load_dwordx4 v78, s[12:15], s80 offen lds
    v_pk_mul_f32 v[152:153], v[120:121], v[64:65]
    v_pk_mul_f32 v[154:155], v[112:113], v[64:65]
    v_pk_fma_f32 v[128:129], v[112:113], v[56:57], v[152:153] neg_lo:[0,0,1] neg_hi:[0,0,1]
    v_pk_fma_f32 v[136:137], v[120:121], v[56:57], v[154:155]
    v_pk_mul_f32 v[152:153], v[122:123], v[66:67]
    v_pk_mul_f32 v[154:155], v[114:115], v[66:67]
    v_pk_fma_f32 v[130:131], v[114:115], v[58:59], v[152:153] neg_lo:[0,0,1] neg_hi:[0,0,1]
    v_pk_fma_f32 v[138:139], v[122:123], v[58:59], v[154:155]
    v_pk_mul_f32 v[152:153], v[124:125], v[68:69]
    v_pk_mul_f32 v[154:155], v[116:117], v[68:69]
    v_pk_fma_f32 v[132:133], v[116:117], v[60:61], v[152:153] neg_lo:[0,0,1] neg_hi:[0,0,1]
    v_pk_fma_f32 v[140:141], v[124:125], v[60:61], v[154:155]
    v_pk_mul_f32 v[152:153], v[126:127], v[70:71]
    s_add_u32 m0, s31, 0
    s_nop 0
    buffer_load_dwordx4 v72, s[12:15], s81 offen lds
    v_pk_mul_f32 v[154:155], v[118:119], v[70:71]
    v_pk_fma_f32 v[134:135], v[118:119], v[62:63], v[152:153] neg_lo:[0,0,1] neg_hi:[0,0,1]
    v_pk_fma_f32 v[142:143], v[126:127], v[62:63], v[154:155]
    v_cvt_pk_bf16_f32 v144, v128, v129
    v_cvt_pk_bf16_f32 v145, v130, v131
    v_cvt_pk_bf16_f32 v146, v136, v137
    v_cvt_pk_bf16_f32 v147, v138, v139
    v_cvt_pk_bf16_f32 v148, v132, v133
    v_cvt_pk_bf16_f32 v149, v134, v135
    v_cvt_pk_bf16_f32 v150, v140, v141
    v_cvt_pk_bf16_f32 v151, v142, v143
    v_mfma_f32_16x16x32_bf16 v[112:115], v[144:147], v[22:25], 0
    v_mfma_f32_16x16x32_bf16 v[120:123], v[144:147], v[20:23], 0
    s_add_u32 m0, s31, 1024
    s_nop 0
    buffer_load_dwordx4 v73, s[12:15], s81 offen lds
    v_mfma_f32_16x16x32_bf16 v[116:119], v[144:147], v[42:45], 0
    v_mfma_f32_16x16x32_bf16 v[124:127], v[144:147], v[40:43], 0
    v_mfma_f32_16x16x32_bf16 v[112:115], v[148:151], v[32:35], v[112:115]
    v_mfma_f32_16x16x32_bf16 v[120:123], v[148:151], v[30:33], v[120:123]
    v_mfma_f32_16x16x32_bf16 v[116:119], v[148:151], v[52:55], v[116:119]
    v_mfma_f32_16x16x32_bf16 v[124:127], v[148:151], v[50:53], v[124:127]
    v_lshlrev_b32 v14, 6, v2
    v_and_b32 v13, 1, v3
    v_lshl_add_u32 v14, v13, 5, v14
    v_lshrrev_b32 v13, 1, v3
    v_lshl_add_u32 v14, v13, 4, v14
    s_add_u32 s70, s76, 12582912
    v_pk_add_f32 v[112:113], v[112:113], v[88:89]
    v_pk_add_f32 v[114:115], v[114:115], v[90:91]
    s_add_u32 m0, s31, 2048
    s_nop 0
    buffer_load_dwordx4 v74, s[12:15], s81 offen lds
    v_pk_add_f32 v[116:117], v[116:117], v[92:93]
    v_pk_add_f32 v[118:119], v[118:119], v[94:95]
    v_pk_add_f32 v[120:121], v[120:121], v[96:97]
    v_pk_add_f32 v[122:123], v[122:123], v[98:99]
    v_pk_add_f32 v[124:125], v[124:125], v[100:101]
    v_pk_add_f32 v[126:127], v[126:127], v[102:103]
    v_pk_add_f32 v[132:133], v[112:113], v[114:115]
    v_pk_mul_f32 v[134:135], v[112:113], v[112:113]
    v_pk_add_f32 v[132:133], v[132:133], v[116:117]
    v_pk_fma_f32 v[134:135], v[114:115], v[114:115], v[134:135]
    v_pk_add_f32 v[132:133], v[132:133], v[118:119]
    v_pk_fma_f32 v[134:135], v[116:117], v[116:117], v[134:135]
    v_add_f32 v128, v132, v133
    s_add_u32 m0, s31, 3072
    s_nop 0
    buffer_load_dwordx4 v75, s[12:15], s81 offen lds
    v_pk_fma_f32 v[134:135], v[118:119], v[118:119], v[134:135]
    v_add_f32 v129, v134, v135
    v_pk_add_f32 v[136:137], v[120:121], v[122:123]
    v_pk_mul_f32 v[138:139], v[120:121], v[120:121]
    v_pk_add_f32 v[136:137], v[136:137], v[124:125]
    v_pk_fma_f32 v[138:139], v[122:123], v[122:123], v[138:139]
    v_pk_add_f32 v[136:137], v[136:137], v[126:127]
    v_pk_fma_f32 v[138:139], v[124:125], v[124:125], v[138:139]
    v_add_f32 v130, v136, v137
    v_pk_fma_f32 v[138:139], v[126:127], v[126:127], v[138:139]
    v_add_f32 v131, v138, v139
    v_cvt_pk_bf16_f32 v104, v112, v113
    v_cvt_pk_bf16_f32 v105, v114, v115
    s_add_u32 m0, s31, 4096
    s_nop 0
    buffer_load_dwordx4 v76, s[12:15], s81 offen lds
    v_permlane32_swap_b32 v128, v130
    v_permlane32_swap_b32 v129, v131
    v_add_f32 v128, v128, v130
    v_add_f32 v129, v129, v131
    v_cvt_pk_bf16_f32 v106, v116, v117
    v_cvt_pk_bf16_f32 v107, v118, v119
    v_permlane16_swap_b32 v128, v129
    v_add_f32 v128, v128, v129
    v_cvt_pk_bf16_f32 v108, v120, v121
    v_cvt_pk_bf16_f32 v109, v122, v123
    v_add_f32_dpp v128, v128, v128 row_ror:8 row_mask:0xf bank_mask:0xf
    v_cvt_pk_bf16_f32 v110, v124, v125
    v_cvt_pk_bf16_f32 v111, v126, v127
    s_add_u32 m0, s31, 5120
    s_nop 0
    buffer_load_dwordx4 v77, s[12:15], s81 offen lds
    v_add_f32_dpp v128, v128, v128 row_ror:4 row_mask:0xf bank_mask:0xf
    s_nop 1
    v_add_f32_dpp v128, v128, v128 row_ror:2 row_mask:0xf bank_mask:0xf
    s_nop 1
    v_add_f32_dpp v128, v128, v128 row_ror:1 row_mask:0xf bank_mask:0xf
    v_mov_b32 v129, v128
    s_nop 1
    v_permlane16_swap_b32 v128, v129
    v_mul_f32 v128, 0x3b000000, v128
    v_mul_f32 v130, v128, v128
    v_fma_f32 v129, v129, s77, -v130
    v_max_f32 v129, 0, v129
    v_add_f32 v130, 0x3727c5ac, v129
    v_rsq_f32 v140, v130
    s_nop 0
    v_mul_f32 v129, v129, v140
    v_fmaak_f32 v129, v129, v140, 0x3727c5ac
    s_add_u32 m0, s31, 6144
    s_nop 0
    buffer_load_dwordx4 v78, s[12:15], s81 offen lds
    v_rsq_f32 v129, v129
    s_nop 0
    v_mul_f32 v140, v140, v129
    v_mul_f32 v141, -v128, v140
    v_mov_b32 v142, v140
    v_mov_b32 v143, v141
    s_nop 0
    v_permlane32_swap_b32 v140, v142
    v_permlane32_swap_b32 v141, v143
    v_pk_fma_f32 v[112:113], v[112:113], v[140:141], v[140:141] op_sel:[0,0,1] op_sel_hi:[1,0,1]
    v_pk_fma_f32 v[114:115], v[114:115], v[140:141], v[140:141] op_sel:[0,0,1] op_sel_hi:[1,0,1]
    v_pk_fma_f32 v[116:117], v[116:117], v[140:141], v[140:141] op_sel:[0,0,1] op_sel_hi:[1,0,1]
    v_pk_fma_f32 v[118:119], v[118:119], v[140:141], v[140:141] op_sel:[0,0,1] op_sel_hi:[1,0,1]
    v_cvt_pk_bf16_f32 v144, v112, v113
    v_cvt_pk_bf16_f32 v145, v114, v115
    v_cvt_pk_bf16_f32 v146, v116, v117
    v_cvt_pk_bf16_f32 v147, v118, v119
    ds_write_b128 v6, v[144:147]
    v_pk_fma_f32 v[120:121], v[120:121], v[142:143], v[142:143] op_sel:[0,0,1] op_sel_hi:[1,0,1]
    v_pk_fma_f32 v[122:123], v[122:123], v[142:143], v[142:143] op_sel:[0,0,1] op_sel_hi:[1,0,1]
    v_pk_fma_f32 v[124:125], v[124:125], v[142:143], v[142:143] op_sel:[0,0,1] op_sel_hi:[1,0,1]
    v_pk_fma_f32 v[126:127], v[126:127], v[142:143], v[142:143] op_sel:[0,0,1] op_sel_hi:[1,0,1]
    v_cvt_pk_bf16_f32 v148, v120, v121
    v_cvt_pk_bf16_f32 v149, v122, v123
    v_cvt_pk_bf16_f32 v150, v124, v125
    v_cvt_pk_bf16_f32 v151, v126, v127
    ds_write_b128 v7, v[148:151]
    v_permlane16_swap_b32 v104, v106
    v_permlane16_swap_b32 v105, v107
    v_permlane16_swap_b32 v108, v110
    v_permlane16_swap_b32 v109, v111
    s_waitcnt lgkmcnt(0)
    s_barrier
    ds_read_b128 v[128:131], v15
    ds_read_b128 v[132:135], v15 offset:4096
    s_waitcnt vmcnt(18) lgkmcnt(1)
    buffer_store_dwordx4 v[128:131], v9, s[8:11], s51 offen sc1
    s_waitcnt lgkmcnt(0)
    buffer_store_dwordx4 v[132:135], v9, s[8:11], s61 offen sc1
    buffer_store_dwordx4 v[104:107], v14, s[8:11], s70 offen sc1
    buffer_store_dwordx4 v[108:111], v14, s[8:11], s70 offen offset:1024 sc1
    s_lshl_b32 s70, s67, 10
    s_add_u32 s70, s70, 147456
    v_add_u32 v12, s70, v5
    v_lshrrev_b32 v13, 5, v1
    v_lshlrev_b32 v13, 3, v13
    v_add_u32 v13, s70, v13
    s_waitcnt vmcnt(21)
    ds_write_b128 v12, v[212:215]
    s_waitcnt lgkmcnt(0)
    ds_read_b64 v[224:225], v13 offset:0
    ds_read_b64 v[226:227], v13 offset:16
    s_waitcnt vmcnt(19)
    ds_read_b64_tr_b16 a[96:97], v11 offset:0
    ds_read_b64_tr_b16 a[98:99], v11 offset:1024
    ds_read_b64_tr_b16 a[100:101], v11 offset:256
    ds_read_b64_tr_b16 a[102:103], v11 offset:1280
    ds_read_b64 v[228:229], v13 offset:32
    ds_read_b64 v[230:231], v13 offset:48
    ds_read_b64 v[232:233], v13 offset:64
    ds_read_b64 v[234:235], v13 offset:80
    ds_read_b64 v[236:237], v13 offset:96
    ds_read_b64 v[238:239], v13 offset:112
    ds_read_b64 v[240:241], v13 offset:128
    ds_read_b64 v[242:243], v13 offset:144
    ds_read_b64 v[244:245], v13 offset:160
    ds_read_b64 v[246:247], v13 offset:176
    ds_read_b64 v[248:249], v13 offset:192
    ds_read_b64 v[250:251], v13 offset:208
    s_waitcnt vmcnt(17)
    ds_read_b64_tr_b16 a[104:105], v11 offset:2048
    ds_read_b64_tr_b16 a[106:107], v11 offset:3072
    ds_read_b64_tr_b16 a[108:109], v11 offset:2304
    ds_read_b64_tr_b16 a[110:111], v11 offset:3328
    v_lshrrev_b32 v12, 5, v1
    v_mul_u32_u24 v12, 1792, v12
    v_and_b32 v13, 3, v1
    v_lshl_add_u32 v12, v13, 3, v12
    v_bfe_u32 v13, v1, 2, 2
    v_lshl_add_u32 v14, v13, 5, v12
    v_lshl_add_u32 v6, v13, 6, v12
    v_bfe_u32 v13, v1, 4, 1
    v_lshl_add_u32 v6, v13, 5, v6
    v_add_u32 v7, 57344, v6
    v_add_u32 v15, 57344, v14
    s_waitcnt vmcnt(15)
    ds_read_b64_tr_b16 a[112:113], v11 offset:4096
    ds_read_b64_tr_b16 a[114:115], v11 offset:5120
    ds_read_b64_tr_b16 a[116:117], v11 offset:4352
    ds_read_b64_tr_b16 a[118:119], v11 offset:5376
    s_lshl_b32 s70, s64, 17
    s_lshl_b32 s71, s67, 15
    s_add_u32 s70, s70, s71
    s_add_u32 s70, s70, 10485760
    s_add_u32 s40, s70, 0
    s_add_u32 s41, s70, 4096
    s_add_u32 s42, s70, 8192
    s_add_u32 s43, s70, 12288
    s_add_u32 s44, s70, 16384
    s_add_u32 s45, s70, 20480
    s_add_u32 s46, s70, 24576
    s_add_u32 s47, s70, 28672
    s_waitcnt vmcnt(13)
    ds_read_b64_tr_b16 a[120:121], v11 offset:6144
    ds_read_b64_tr_b16 a[122:123], v11 offset:7168
    ds_read_b64_tr_b16 a[124:125], v11 offset:6400
    ds_read_b64_tr_b16 a[126:127], v11 offset:7424
    v_mov_b32 v120, 0
    v_mov_b32 v121, 0
    v_mov_b32 v122, 0
    v_mov_b32 v123, 0
    v_mov_b32 v124, 0
    v_mov_b32 v125, 0
    v_mov_b32 v126, 0
    v_mov_b32 v127, 0
    s_lshl_b32 s71, s64, 2
    s_bfe_u32 s72, s65, 0x10002
    s_lshl_b32 s72, s72, 1
    s_add_u32 s71, s71, s72
    s_waitcnt lgkmcnt(15)
    s_add_u32 m0, s100, 0
    s_add_u32 s74, s26, 32768
    buffer_load_dwordx4 v10, s[16:19], s74 offen lds
    s_lshl_b32 s71, s71, 4
    s_lshl_b32 s72, s67, 2
    s_add_u32 s71, s71, s72
    s_mul_i32 s71, s71, 7168
    s_add_u32 s53, s71, 14680064
    s_add_u32 s54, s53, 114688
    s_lshl_b32 s55, s64, 7
    s_bfe_u32 s71, s65, 0x10002
    s_lshl_b32 s71, s71, 4
    s_add_u32 s55, s55, s71
    s_lshl_b32 s71, s67, 1
    s_add_u32 m0, s100, 1024
    s_add_u32 s74, s26, 40960
    buffer_load_dwordx4 v10, s[16:19], s74 offen lds
    s_add_u32 s55, s55, s71
    s_lshl_b32 s55, s55, 10
    s_lshr_b32 s71, s65, 3
    s_lshl_b32 s71, s71, 2
    s_and_b32 s77, s65, 3
    s_add_u32 s71, s71, s77
    s_lshl_b32 s77, s71, 7
    s_add_u32 s55, s55, s77
    s_add_u32 s56, s55, 8192
    s_add_u32 s57, s55, 12582912
    s_add_u32 s60, s56, 12582912
    v_lshlrev_b32 v8, 15, v3
    s_waitcnt lgkmcnt(8)
    s_add_u32 m0, s100, 2048
    s_add_u32 s74, s26, 49152
    buffer_load_dwordx4 v10, s[16:19], s74 offen lds
    v_bfe_u32 v12, v1, 3, 1
    v_lshl_add_u32 v8, v12, 10, v8
    v_and_b32 v12, 7, v1
    v_lshlrev_b32 v9, 4, v12
    v_add_u32 v8, v8, v9
    s_mov_b32 s72, 0xbdd2d3e8
    s_mov_b32 s73, 0xbdd2d3e8
    v_mov_b32 v60, 0xc0135761
    v_mov_b32 v61, 0xc0135761
    v_lshlrev_b32 v62, 7, v1
    v_mov_b32 v13, 0x7ffffff0
    s_add_u32 m0, s100, 3072
    s_add_u32 s74, s26, 57344
    buffer_load_dwordx4 v10, s[16:19], s74 offen lds
    v_cmp_gt_u32 vcc, 8, v1
    s_nop 1
    v_cndmask_b32 v62, v13, v62, vcc
    v_lshlrev_b32 v64, 16, v224
    v_and_b32 v65, s78, v224
    v_lshlrev_b32 v66, 16, v225
    v_and_b32 v67, s78, v225
    v_lshlrev_b32 v68, 16, v226
    v_and_b32 v69, s78, v226
    v_lshlrev_b32 v70, 16, v227
    v_and_b32 v71, s78, v227
    v_lshlrev_b32 v72, 16, v228
    s_waitcnt lgkmcnt(4)
    s_add_u32 m0, s100, 4096
    s_add_u32 s74, s26, 65536
    buffer_load_dwordx4 v10, s[16:19], s74 offen lds
    v_and_b32 v73, s78, v228
    v_lshlrev_b32 v74, 16, v229
    v_and_b32 v75, s78, v229
    v_lshlrev_b32 v76, 16, v230
    v_and_b32 v77, s78, v230
    v_lshlrev_b32 v78, 16, v231
    v_and_b32 v79, s78, v231
    v_lshlrev_b32 v80, 16, v232
    v_and_b32 v81, s78, v232
    v_lshlrev_b32 v82, 16, v233
    v_and_b32 v83, s78, v233
    v_lshlrev_b32 v84, 16, v234
    s_add_u32 m0, s100, 5120
    s_add_u32 s74, s26, 73728
    buffer_load_dwordx4 v10, s[16:19], s74 offen lds
    v_and_b32 v85, s78, v234
    v_lshlrev_b32 v86, 16, v235
    v_and_b32 v87, s78, v235
    v_lshlrev_b32 v88, 16, v236
    v_and_b32 v89, s78, v236
    v_lshlrev_b32 v90, 16, v237
    v_and_b32 v91, s78, v237
    v_lshlrev_b32 v92, 16, v238
    v_and_b32 v93, s78, v238
    v_lshlrev_b32 v94, 16, v239
    v_and_b32 v95, s78, v239
    s_waitcnt lgkmcnt(0)
    s_add_u32 m0, s100, 6144
    s_add_u32 s74, s26, 81920
    buffer_load_dwordx4 v10, s[16:19], s74 offen lds
    v_lshlrev_b32 v96, 16, v240
    v_and_b32 v97, s78, v240
    v_lshlrev_b32 v98, 16, v241
    v_and_b32 v99, s78, v241
    v_lshlrev_b32 v100, 16, v242
    v_and_b32 v101, s78, v242
    v_lshlrev_b32 v102, 16, v243
    v_and_b32 v103, s78, v243
    v_lshlrev_b32 v104, 16, v244
    v_and_b32 v105, s78, v244
    v_lshlrev_b32 v106, 16, v245
    v_and_b32 v107, s78, v245
    s_add_u32 m0, s100, 7168
    s_add_u32 s74, s26, 90112
    buffer_load_dwordx4 v10, s[16:19], s74 offen lds
    v_lshlrev_b32 v108, 16, v246
    v_and_b32 v109, s78, v246
    v_lshlrev_b32 v110, 16, v247
    v_and_b32 v111, s78, v247
    v_lshlrev_b32 v112, 16, v248
    v_and_b32 v113, s78, v248
    v_lshlrev_b32 v114, 16, v249
    v_and_b32 v115, s78, v249
    v_lshlrev_b32 v116, 16, v250
    v_and_b32 v117, s78, v250
    v_lshlrev_b32 v118, 16, v251
    v_and_b32 v119, s78, v251
    s_waitcnt vmcnt(6)
    ds_read_b64_tr_b16 a[128:129], v11 offset:0
    ds_read_b64_tr_b16 a[130:131], v11 offset:1024
    ds_read_b64_tr_b16 a[132:133], v11 offset:256
    ds_read_b64_tr_b16 a[134:135], v11 offset:1280
    s_waitcnt vmcnt(4)
    ds_read_b64_tr_b16 a[136:137], v11 offset:2048
    ds_read_b64_tr_b16 a[138:139], v11 offset:3072
    ds_read_b64_tr_b16 a[140:141], v11 offset:2304
    ds_read_b64_tr_b16 a[142:143], v11 offset:3328
    s_waitcnt vmcnt(2)
    ds_read_b64_tr_b16 a[144:145], v11 offset:4096
    ds_read_b64_tr_b16 a[146:147], v11 offset:5120
    ds_read_b64_tr_b16 a[148:149], v11 offset:4352
    ds_read_b64_tr_b16 a[150:151], v11 offset:5376
    s_waitcnt vmcnt(0)
    ds_read_b64_tr_b16 a[152:153], v11 offset:6144
    ds_read_b64_tr_b16 a[154:155], v11 offset:7168
    ds_read_b64_tr_b16 a[156:157], v11 offset:6400
    ds_read_b64_tr_b16 a[158:159], v11 offset:7424
    s_waitcnt lgkmcnt(12)
    s_add_u32 m0, s100, 0
    s_add_u32 s74, s26, 98304
    buffer_load_dwordx4 v10, s[16:19], s74 offen lds
    s_add_u32 m0, s100, 1024
    s_add_u32 s74, s26, 106496
    buffer_load_dwordx4 v10, s[16:19], s74 offen lds
    s_waitcnt lgkmcnt(8)
    s_add_u32 m0, s100, 2048
    s_add_u32 s74, s27, 0
    buffer_load_dwordx4 v10, s[16:19], s74 offen lds
    s_add_u32 m0, s100, 3072
    s_add_u32 s74, s27, 8192
    buffer_load_dwordx4 v10, s[16:19], s74 offen lds
    s_waitcnt lgkmcnt(4)
    s_add_u32 m0, s100, 4096
    s_add_u32 s74, s27, 16384
    buffer_load_dwordx4 v10, s[16:19], s74 offen lds
    s_add_u32 m0, s100, 5120
    s_add_u32 s74, s27, 24576
    buffer_load_dwordx4 v10, s[16:19], s74 offen lds
    s_waitcnt lgkmcnt(0)
    s_add_u32 m0, s100, 6144
    s_add_u32 s74, s27, 32768
    buffer_load_dwordx4 v10, s[16:19], s74 offen lds
    s_add_u32 m0, s100, 7168
    s_add_u32 s74, s27, 40960
    buffer_load_dwordx4 v10, s[16:19], s74 offen lds
    s_barrier
    buffer_load_dwordx4 v[128:131], v5, s[8:11], s40 offen offset:0 sc1
    buffer_load_dwordx4 v[132:135], v5, s[8:11], s40 offen offset:1024 sc1
    buffer_load_dwordx4 v[136:139], v5, s[8:11], s40 offen offset:2048 sc1
    buffer_load_dwordx4 v[140:143], v5, s[8:11], s40 offen offset:3072 sc1
    buffer_load_dwordx4 v[144:147], v5, s[8:11], s41 offen offset:0 sc1
    buffer_load_dwordx4 v[148:151], v5, s[8:11], s41 offen offset:1024 sc1
    buffer_load_dwordx4 v[152:155], v5, s[8:11], s41 offen offset:2048 sc1
    buffer_load_dwordx4 v[156:159], v5, s[8:11], s41 offen offset:3072 sc1
    buffer_load_dwordx4 v[160:163], v5, s[8:11], s42 offen offset:0 sc1
    buffer_load_dwordx4 v[164:167], v5, s[8:11], s42 offen offset:1024 sc1
    ds_read_b64_tr_b16 v[16:17], v6 offset:0
    ds_read_b64_tr_b16 v[18:19], v6 offset:896
    ds_read_b64_tr_b16 v[20:21], v6 offset:256
    ds_read_b64_tr_b16 v[22:23], v6 offset:1152
    ds_read_b64_tr_b16 v[24:25], v6 offset:512
    ds_read_b64_tr_b16 v[26:27], v6 offset:1408
    ds_read_b64_tr_b16 v[28:29], v6 offset:3584
    ds_read_b64_tr_b16 v[30:31], v6 offset:4480
    ds_read_b64_tr_b16 v[32:33], v6 offset:3840
    ds_read_b64_tr_b16 v[34:35], v6 offset:4736
    s_waitcnt vmcnt(6)
    v_max3_u32 v40, v128, v129, v130
    v_max3_u32 v40, v40, v131, v132
    v_max3_u32 v40, v40, v133, v134
    v_max3_u32 v40, v40, v135, v136
    v_max3_u32 v40, v40, v137, v138
    v_max3_u32 v40, v40, v139, v140
    v_max3_u32 v40, v40, v141, v142
    v_max3_u32 v40, v40, v143, v143
    v_cmp_eq_u32 vcc, -1, v40
    s_cbranch_vccnz L_retry_12
L_cont_13:
    s_waitcnt lgkmcnt(6)
    v_mfma_f32_32x32x16_bf16 v[64:79], v[16:19], v[128:131], v[64:79]
    ds_read_b64_tr_b16 v[36:37], v6 offset:7168
    ds_read_b64_tr_b16 v[38:39], v6 offset:8064
    v_mfma_f32_32x32x16_bf16 v[80:95], v[20:23], v[128:131], v[80:95]
    ds_read_b64_tr_b16 v[16:17], v6 offset:7424
    ds_read_b64_tr_b16 v[18:19], v6 offset:8320
    buffer_load_dwordx4 v[168:171], v5, s[8:11], s42 offen offset:2048 sc1
    s_waitcnt lgkmcnt(6)
    v_mfma_f32_32x32x16_bf16 v[96:111], v[24:27], v[128:131], v[96:111]
    ds_read_b64_tr_b16 v[20:21], v6 offset:10752
    ds_read_b64_tr_b16 v[22:23], v6 offset:11648
    v_mfma_f32_32x32x16_bf16 v[64:79], v[28:31], v[132:135], v[64:79]
    ds_read_b64_tr_b16 v[24:25], v6 offset:11008
    ds_read_b64_tr_b16 v[26:27], v6 offset:11904
    s_waitcnt lgkmcnt(6)
    v_mfma_f32_32x32x16_bf16 v[80:95], v[32:35], v[132:135], v[80:95]
    ds_read_b64_tr_b16 v[28:29], v6 offset:14336
    ds_read_b64_tr_b16 v[30:31], v6 offset:15232
    buffer_load_dwordx4 v[172:175], v5, s[8:11], s42 offen offset:3072 sc1
    v_mfma_f32_32x32x16_bf16 v[64:79], v[36:39], v[136:139], v[64:79]
    ds_read_b64_tr_b16 v[32:33], v6 offset:14592
    ds_read_b64_tr_b16 v[34:35], v6 offset:15488
    s_waitcnt vmcnt(4)
    v_max3_u32 v40, v144, v145, v146
    v_max3_u32 v40, v40, v147, v148
    v_max3_u32 v40, v40, v149, v150
    s_waitcnt lgkmcnt(6)
    v_mfma_f32_32x32x16_bf16 v[80:95], v[16:19], v[136:139], v[80:95]
    ds_read_b64_tr_b16 v[36:37], v6 offset:17920
    ds_read_b64_tr_b16 v[38:39], v6 offset:18816
    buffer_load_dwordx4 v[176:179], v5, s[8:11], s43 offen offset:0 sc1
    v_mfma_f32_32x32x16_bf16 v[64:79], v[20:23], v[140:143], v[64:79]
    ds_read_b64_tr_b16 v[16:17], v6 offset:18176
    ds_read_b64_tr_b16 v[18:19], v6 offset:19072
    v_max3_u32 v40, v40, v151, v152
    v_max3_u32 v40, v40, v153, v154
    v_max3_u32 v40, v40, v155, v156
    s_waitcnt lgkmcnt(6)
    v_mfma_f32_32x32x16_bf16 v[80:95], v[24:27], v[140:143], v[80:95]
    ds_read_b64_tr_b16 v[20:21], v6 offset:21504
    ds_read_b64_tr_b16 v[22:23], v6 offset:22400
    buffer_load_dwordx4 v[180:183], v5, s[8:11], s43 offen offset:1024 sc1
    v_max3_u32 v40, v40, v157, v158
    v_max3_u32 v40, v40, v159, v159
    v_cmp_eq_u32 vcc, -1, v40
    s_cbranch_vccnz L_retry_14
L_cont_15:
    v_mfma_f32_32x32x16_bf16 v[64:79], v[28:31], v[144:147], v[64:79]
    ds_read_b64_tr_b16 v[24:25], v6 offset:21760
    ds_read_b64_tr_b16 v[26:27], v6 offset:22656
    s_waitcnt lgkmcnt(6)
    v_mfma_f32_32x32x16_bf16 v[80:95], v[32:35], v[144:147], v[80:95]
    ds_read_b64_tr_b16 v[28:29], v14 offset:768
    ds_read_b64_tr_b16 v[30:31], v14 offset:1664
    buffer_load_dwordx4 v[184:187], v5, s[8:11], s43 offen offset:2048 sc1
    v_mfma_f32_32x32x16_bf16 v[64:79], v[36:39], v[148:151], v[64:79]
    ds_read_b64_tr_b16 v[32:33], v6 offset:25088
    ds_read_b64_tr_b16 v[34:35], v6 offset:25984
    s_waitcnt lgkmcnt(6)
    v_mfma_f32_32x32x16_bf16 v[80:95], v[16:19], v[148:151], v[80:95]
    ds_read_b64_tr_b16 v[36:37], v6 offset:25344
    ds_read_b64_tr_b16 v[38:39], v6 offset:26240
    buffer_load_dwordx4 v[188:191], v5, s[8:11], s43 offen offset:3072 sc1
    v_mfma_f32_32x32x16_bf16 v[64:79], v[20:23], v[152:155], v[64:79]
    ds_read_b64_tr_b16 v[16:17], v6 offset:28672
    ds_read_b64_tr_b16 v[18:19], v6 offset:29568
    s_waitcnt lgkmcnt(6)
    v_mfma_f32_32x32x16_bf16 v[80:95], v[24:27], v[152:155], v[80:95]
    ds_read_b64_tr_b16 v[20:21], v6 offset:28928
    ds_read_b64_tr_b16 v[22:23], v6 offset:29824
    buffer_load_dwordx4 v[192:195], v5, s[8:11], s44 offen offset:0 sc1
    v_mfma_f32_32x32x16_bf16 v[112:127], v[28:31], v[128:131], v[112:127]
    ds_read_b64_tr_b16 v[24:25], v6 offset:32256
    ds_read_b64_tr_b16 v[26:27], v6 offset:33152
    s_waitcnt vmcnt(5)
    v_max3_u32 v40, v160, v161, v162
    v_max3_u32 v40, v40, v163, v164
    v_max3_u32 v40, v40, v165, v166
    s_waitcnt lgkmcnt(6)
    v_mfma_f32_32x32x16_bf16 v[64:79], v[32:35], v[156:159], v[64:79]
    ds_read_b64_tr_b16 v[28:29], v6 offset:32512
    ds_read_b64_tr_b16 v[30:31], v6 offset:33408
    v_max3_u32 v40, v40, v167, v168
    v_max3_u32 v40, v40, v169, v170
    v_max3_u32 v40, v40, v171, v172
    v_mfma_f32_32x32x16_bf16 v[80:95], v[36:39], v[156:159], v[80:95]
    ds_read_b64_tr_b16 v[32:33], v6 offset:35840
    ds_read_b64_tr_b16 v[34:35], v6 offset:36736
    buffer_load_dwordx4 v[196:199], v5, s[8:11], s44 offen offset:1024 sc1
    v_max3_u32 v40, v40, v173, v174
    v_max3_u32 v40, v40, v175, v175
    v_cmp_eq_u32 vcc, -1, v40
    s_cbranch_vccnz L_retry_16
L_cont_17:
    s_waitcnt lgkmcnt(6)
    v_mfma_f32_32x32x16_bf16 v[64:79], v[16:19], v[160:163], v[64:79]
    ds_read_b64_tr_b16 v[36:37], v6 offset:36096
    ds_read_b64_tr_b16 v[38:39], v6 offset:36992
    v_mfma_f32_32x32x16_bf16 v[80:95], v[20:23], v[160:163], v[80:95]
    ds_read_b64_tr_b16 v[16:17], v6 offset:39424
    ds_read_b64_tr_b16 v[18:19], v6 offset:40320
    buffer_load_dwordx4 v[200:203], v5, s[8:11], s44 offen offset:2048 sc1
    s_waitcnt lgkmcnt(6)
    v_mfma_f32_32x32x16_bf16 v[64:79], v[24:27], v[164:167], v[64:79]
    ds_read_b64_tr_b16 v[20:21], v6 offset:39680
    ds_read_b64_tr_b16 v[22:23], v6 offset:40576
    v_mfma_f32_32x32x16_bf16 v[80:95], v[28:31], v[164:167], v[80:95]
    ds_read_b64_tr_b16 v[24:25], v6 offset:4096
    ds_read_b64_tr_b16 v[26:27], v6 offset:4992
    buffer_load_dwordx4 v[204:207], v5, s[8:11], s44 offen offset:3072 sc1
    s_waitcnt lgkmcnt(6)
    v_mfma_f32_32x32x16_bf16 v[64:79], v[32:35], v[168:171], v[64:79]
    ds_read_b64_tr_b16 v[28:29], v6 offset:43008
    ds_read_b64_tr_b16 v[30:31], v6 offset:43904
    v_mfma_f32_32x32x16_bf16 v[80:95], v[36:39], v[168:171], v[80:95]
    ds_read_b64_tr_b16 v[32:33], v6 offset:43264
    ds_read_b64_tr_b16 v[34:35], v6 offset:44160
    buffer_load_dwordx4 v[208:211], v5, s[8:11], s45 offen offset:0 sc1
    s_waitcnt lgkmcnt(6)
    v_mfma_f32_32x32x16_bf16 v[64:79], v[16:19], v[172:175], v[64:79]
    ds_read_b64_tr_b16 v[36:37], v6 offset:46592
    ds_read_b64_tr_b16 v[38:39], v6 offset:47488
    s_waitcnt vmcnt(5)
    v_max3_u32 v40, v176, v177, v178
    v_max3_u32 v40, v40, v179, v180
    v_max3_u32 v40, v40, v181, v182
    v_mfma_f32_32x32x16_bf16 v[80:95], v[20:23], v[172:175], v[80:95]
    ds_read_b64_tr_b16 v[16:17], v6 offset:46848
    ds_read_b64_tr_b16 v[18:19], v6 offset:47744
    buffer_load_dwordx4 v[212:215], v5, s[8:11], s45 offen offset:1024 sc1
    s_waitcnt lgkmcnt(6)
    v_mfma_f32_32x32x16_bf16 v[96:111], v[24:27], v[132:135], v[96:111]
    ds_read_b64_tr_b16 v[20:21], v6 offset:50176
    ds_read_b64_tr_b16 v[22:23], v6 offset:51072
    v_max3_u32 v40, v40, v183, v184
    v_max3_u32 v40, v40, v185, v186
    v_max3_u32 v40, v40, v187, v188
    v_max3_u32 v40, v40, v189, v190
    v_max3_u32 v40, v40, v191, v191
    v_cmp_eq_u32 vcc, -1, v40
    s_cbranch_vccnz L_retry_18
L_cont_19:
    v_mfma_f32_32x32x16_bf16 v[64:79], v[28:31], v[176:179], v[64:79]
    ds_read_b64_tr_b16 v[24:25], v6 offset:50432
    ds_read_b64_tr_b16 v[26:27], v6 offset:51328
    s_waitcnt lgkmcnt(6)
    v_mfma_f32_32x32x16_bf16 v[80:95], v[32:35], v[176:179], v[80:95]
    ds_read_b64_tr_b16 v[28:29], v6 offset:53760
    ds_read_b64_tr_b16 v[30:31], v6 offset:54656
    buffer_load_dwordx4 v[216:219], v5, s[8:11], s45 offen offset:2048 sc1
    v_mfma_f32_32x32x16_bf16 v[64:79], v[36:39], v[180:183], v[64:79]
    ds_read_b64_tr_b16 v[32:33], v6 offset:54016
    ds_read_b64_tr_b16 v[34:35], v6 offset:54912
    s_waitcnt lgkmcnt(6)
    v_mfma_f32_32x32x16_bf16 v[80:95], v[16:19], v[180:183], v[80:95]
    ds_read_b64_tr_b16 v[36:37], v7 offset:0
    ds_read_b64_tr_b16 v[38:39], v7 offset:896
    buffer_load_dwordx4 v[220:223], v5, s[8:11], s45 offen offset:3072 sc1
    v_mfma_f32_32x32x16_bf16 v[64:79], v[20:23], v[184:187], v[64:79]
    ds_read_b64_tr_b16 v[16:17], v7 offset:256
    ds_read_b64_tr_b16 v[18:19], v7 offset:1152
    s_waitcnt vmcnt(4)
    v_max3_u32 v40, v192, v193, v194
    v_max3_u32 v40, v40, v195, v196
    v_max3_u32 v40, v40, v197, v198
    s_waitcnt lgkmcnt(6)
    v_mfma_f32_32x32x16_bf16 v[80:95], v[24:27], v[184:187], v[80:95]
    ds_read_b64_tr_b16 v[20:21], v14 offset:4352
    ds_read_b64_tr_b16 v[22:23], v14 offset:5248
    buffer_load_dwordx4 v[224:227], v5, s[8:11], s46 offen offset:0 sc1
    v_mfma_f32_32x32x16_bf16 v[64:79], v[28:31], v[188:191], v[64:79]
    ds_read_b64_tr_b16 v[24:25], v7 offset:3584
    ds_read_b64_tr_b16 v[26:27], v7 offset:4480
    v_max3_u32 v40, v40, v199, v200
    v_max3_u32 v40, v40, v201, v202
    v_max3_u32 v40, v40, v203, v204
    s_waitcnt lgkmcnt(6)
    v_mfma_f32_32x32x16_bf16 v[80:95], v[32:35], v[188:191], v[80:95]
    ds_read_b64_tr_b16 v[28:29], v7 offset:3840
    ds_read_b64_tr_b16 v[30:31], v7 offset:4736
    buffer_load_dwordx4 v[228:231], v5, s[8:11], s46 offen offset:1024 sc1
    v_max3_u32 v40, v40, v205, v206
    v_max3_u32 v40, v40, v207, v207
    v_cmp_eq_u32 vcc, -1, v40
    s_cbranch_vccnz L_retry_20
L_cont_21:
    v_mfma_f32_32x32x16_bf16 v[64:79], v[36:39], v[192:195], v[64:79]
    ds_read_b64_tr_b16 v[32:33], v7 offset:7168
    ds_read_b64_tr_b16 v[34:35], v7 offset:8064
    s_waitcnt lgkmcnt(6)
    v_mfma_f32_32x32x16_bf16 v[80:95], v[16:19], v[192:195], v[80:95]
    ds_read_b64_tr_b16 v[36:37], v7 offset:7424
    ds_read_b64_tr_b16 v[38:39], v7 offset:8320
    buffer_load_dwordx4 v[232:235], v5, s[8:11], s46 offen offset:2048 sc1
    v_mfma_f32_32x32x16_bf16 v[112:127], v[20:23], v[132:135], v[112:127]
    ds_read_b64_tr_b16 v[16:17], v7 offset:10752
    ds_read_b64_tr_b16 v[18:19], v7 offset:11648
    s_waitcnt lgkmcnt(6)
    v_mfma_f32_32x32x16_bf16 v[64:79], v[24:27], v[196:199], v[64:79]
    ds_read_b64_tr_b16 v[20:21], v7 offset:11008
    ds_read_b64_tr_b16 v[22:23], v7 offset:11904
    v_mfma_f32_32x32x16_bf16 v[80:95], v[28:31], v[196:199], v[80:95]
    ds_read_b64_tr_b16 v[24:25], v7 offset:14336
    ds_read_b64_tr_b16 v[26:27], v7 offset:15232
    buffer_load_dwordx4 v[236:239], v5, s[8:11], s46 offen offset:3072 sc1
    s_waitcnt lgkmcnt(6)
    v_mfma_f32_32x32x16_bf16 v[64:79], v[32:35], v[200:203], v[64:79]
    ds_read_b64_tr_b16 v[28:29], v7 offset:14592
    ds_read_b64_tr_b16 v[30:31], v7 offset:15488
    s_waitcnt vmcnt(4)
    v_max3_u32 v40, v208, v209, v210
    v_max3_u32 v40, v40, v211, v212
    v_max3_u32 v40, v40, v213, v214
    v_mfma_f32_32x32x16_bf16 v[80:95], v[36:39], v[200:203], v[80:95]
    ds_read_b64_tr_b16 v[32:33], v7 offset:17920
    ds_read_b64_tr_b16 v[34:35], v7 offset:18816
    buffer_load_dwordx4 v[240:243], v5, s[8:11], s47 offen offset:0 sc1
    s_waitcnt lgkmcnt(6)
    v_mfma_f32_32x32x16_bf16 v[64:79], v[16:19], v[204:207], v[64:79]
    ds_read_b64_tr_b16 v[36:37], v7 offset:18176
    ds_read_b64_tr_b16 v[38:39], v7 offset:19072
    v_max3_u32 v40, v40, v215, v216
    v_max3_u32 v40, v40, v217, v218
    v_max3_u32 v40, v40, v219, v220
    v_mfma_f32_32x32x16_bf16 v[80:95], v[20:23], v[204:207], v[80:95]
    ds_read_b64_tr_b16 v[16:17], v7 offset:21504
    ds_read_b64_tr_b16 v[18:19], v7 offset:22400
    buffer_load_dwordx4 v[244:247], v5, s[8:11], s47 offen offset:1024 sc1
    v_max3_u32 v40, v40, v221, v222
    v_max3_u32 v40, v40, v223, v223
    v_cmp_eq_u32 vcc, -1, v40
    s_cbranch_vccnz L_retry_22
L_cont_23:
    s_waitcnt lgkmcnt(6)
    v_mfma_f32_32x32x16_bf16 v[64:79], v[24:27], v[208:211], v[64:79]
    ds_read_b64_tr_b16 v[20:21], v7 offset:21760
    ds_read_b64_tr_b16 v[22:23], v7 offset:22656
    v_mfma_f32_32x32x16_bf16 v[80:95], v[28:31], v[208:211], v[80:95]
    ds_read_b64_tr_b16 v[24:25], v6 offset:7680
    ds_read_b64_tr_b16 v[26:27], v6 offset:8576
    buffer_load_dwordx4 v[248:251], v5, s[8:11], s47 offen offset:2048 sc1
    s_waitcnt lgkmcnt(6)
    v_mfma_f32_32x32x16_bf16 v[64:79], v[32:35], v[212:215], v[64:79]
    ds_read_b64_tr_b16 v[28:29], v7 offset:25088
    ds_read_b64_tr_b16 v[30:31], v7 offset:25984
    v_mfma_f32_32x32x16_bf16 v[80:95], v[36:39], v[212:215], v[80:95]
    ds_read_b64_tr_b16 v[32:33], v7 offset:25344
    ds_read_b64_tr_b16 v[34:35], v7 offset:26240
    buffer_load_dwordx4 v[252:255], v5, s[8:11], s47 offen offset:3072 sc1
    s_waitcnt lgkmcnt(6)
    v_mfma_f32_32x32x16_bf16 v[64:79], v[16:19], v[216:219], v[64:79]
    ds_read_b64_tr_b16 v[36:37], v7 offset:28672
    ds_read_b64_tr_b16 v[38:39], v7 offset:29568
    v_mfma_f32_32x32x16_bf16 v[80:95], v[20:23], v[216:219], v[80:95]
    ds_read_b64_tr_b16 v[16:17], v7 offset:28928
    ds_read_b64_tr_b16 v[18:19], v7 offset:29824
    s_waitcnt vmcnt(4)
    v_max3_u32 v40, v224, v225, v226
    v_max3_u32 v40, v40, v227, v228
    v_max3_u32 v40, v40, v229, v230
    s_waitcnt lgkmcnt(6)
    v_mfma_f32_32x32x16_bf16 v[96:111], v[24:27], v[136:139], v[96:111]
    ds_read_b64_tr_b16 v[20:21], v7 offset:32256
    ds_read_b64_tr_b16 v[22:23], v7 offset:33152
    v_max3_u32 v40, v40, v231, v232
    v_max3_u32 v40, v40, v233, v234
    v_max3_u32 v40, v40, v235, v236
    v_mfma_f32_32x32x16_bf16 v[64:79], v[28:31], v[220:223], v[64:79]
    ds_read_b64_tr_b16 v[24:25], v7 offset:32512
    ds_read_b64_tr_b16 v[26:27], v7 offset:33408
    v_max3_u32 v40, v40, v237, v238
    v_max3_u32 v40, v40, v239, v239
    v_cmp_eq_u32 vcc, -1, v40
    s_waitcnt lgkmcnt(6)
    v_mfma_f32_32x32x16_bf16 v[80:95], v[32:35], v[220:223], v[80:95]
    ds_read_b64_tr_b16 v[28:29], v7 offset:35840
    ds_read_b64_tr_b16 v[30:31], v7 offset:36736
    s_cbranch_vccnz L_retry_24
L_cont_25:
    v_mfma_f32_32x32x16_bf16 v[64:79], v[36:39], v[224:227], v[64:79]
    ds_read_b64_tr_b16 v[32:33], v7 offset:36096
    ds_read_b64_tr_b16 v[34:35], v7 offset:36992
    s_waitcnt lgkmcnt(6)
    v_mfma_f32_32x32x16_bf16 v[80:95], v[16:19], v[224:227], v[80:95]
    ds_read_b64_tr_b16 v[36:37], v7 offset:39424
    ds_read_b64_tr_b16 v[38:39], v7 offset:40320
    v_mfma_f32_32x32x16_bf16 v[64:79], v[20:23], v[228:231], v[64:79]
    ds_read_b64_tr_b16 v[16:17], v7 offset:39680
    ds_read_b64_tr_b16 v[18:19], v7 offset:40576
    s_waitcnt lgkmcnt(6)
    v_mfma_f32_32x32x16_bf16 v[80:95], v[24:27], v[228:231], v[80:95]
    ds_read_b64_tr_b16 v[20:21], v14 offset:7936
    ds_read_b64_tr_b16 v[22:23], v14 offset:8832
    v_mfma_f32_32x32x16_bf16 v[64:79], v[28:31], v[232:235], v[64:79]
    ds_read_b64_tr_b16 v[24:25], v7 offset:43008
    ds_read_b64_tr_b16 v[26:27], v7 offset:43904
    s_waitcnt lgkmcnt(6)
    v_mfma_f32_32x32x16_bf16 v[80:95], v[32:35], v[232:235], v[80:95]
    ds_read_b64_tr_b16 v[28:29], v7 offset:43264
    ds_read_b64_tr_b16 v[30:31], v7 offset:44160
    s_waitcnt vmcnt(0)
    v_max3_u32 v40, v240, v241, v242
    v_max3_u32 v40, v40, v243, v244
    v_max3_u32 v40, v40, v245, v246
    v_mfma_f32_32x32x16_bf16 v[64:79], v[36:39], v[236:239], v[64:79]
    ds_read_b64_tr_b16 v[32:33], v7 offset:46592
    ds_read_b64_tr_b16 v[34:35], v7 offset:47488
    v_max3_u32 v40, v40, v247, v248
    v_max3_u32 v40, v40, v249, v250
    v_max3_u32 v40, v40, v251, v252
    s_waitcnt lgkmcnt(6)
    v_mfma_f32_32x32x16_bf16 v[80:95], v[16:19], v[236:239], v[80:95]
    ds_read_b64_tr_b16 v[36:37], v7 offset:46848
    ds_read_b64_tr_b16 v[38:39], v7 offset:47744
    v_max3_u32 v40, v40, v253, v254
    v_max3_u32 v40, v40, v255, v255
    v_cmp_eq_u32 vcc, -1, v40
    v_mfma_f32_32x32x16_bf16 v[112:127], v[20:23], v[136:139], v[112:127]
    ds_read_b64_tr_b16 v[16:17], v7 offset:50176
    ds_read_b64_tr_b16 v[18:19], v7 offset:51072
    s_cbranch_vccnz L_retry_26
L_cont_27:
    s_waitcnt lgkmcnt(6)
    v_mfma_f32_32x32x16_bf16 v[64:79], v[24:27], v[240:243], v[64:79]
    ds_read_b64_tr_b16 v[20:21], v7 offset:50432
    ds_read_b64_tr_b16 v[22:23], v7 offset:51328
    v_mfma_f32_32x32x16_bf16 v[80:95], v[28:31], v[240:243], v[80:95]
    ds_read_b64_tr_b16 v[24:25], v7 offset:53760
    ds_read_b64_tr_b16 v[26:27], v7 offset:54656
    s_waitcnt lgkmcnt(6)
    v_mfma_f32_32x32x16_bf16 v[64:79], v[32:35], v[244:247], v[64:79]
    ds_read_b64_tr_b16 v[28:29], v7 offset:54016
    ds_read_b64_tr_b16 v[30:31], v7 offset:54912
    v_mfma_f32_32x32x16_bf16 v[80:95], v[36:39], v[244:247], v[80:95]
    ds_read_b64_tr_b16 v[32:33], v6 offset:11264
    ds_read_b64_tr_b16 v[34:35], v6 offset:12160
    s_waitcnt lgkmcnt(6)
    v_mfma_f32_32x32x16_bf16 v[64:79], v[16:19], v[248:251], v[64:79]
    ds_read_b64_tr_b16 v[36:37], v14 offset:11520
    ds_read_b64_tr_b16 v[38:39], v14 offset:12416
    v_mfma_f32_32x32x16_bf16 v[80:95], v[20:23], v[248:251], v[80:95]
    ds_read_b64_tr_b16 v[16:17], v6 offset:14848
    ds_read_b64_tr_b16 v[18:19], v6 offset:15744
    s_waitcnt lgkmcnt(6)
    v_mfma_f32_32x32x16_bf16 v[64:79], v[24:27], v[252:255], v[64:79]
    ds_read_b64_tr_b16 v[20:21], v14 offset:15104
    ds_read_b64_tr_b16 v[22:23], v14 offset:16000
    v_mfma_f32_32x32x16_bf16 v[80:95], v[28:31], v[252:255], v[80:95]
    ds_read_b64_tr_b16 v[24:25], v6 offset:18432
    ds_read_b64_tr_b16 v[26:27], v6 offset:19328
    s_add_u32 s71, s3, 0
    s_and_b32 s71, s71, 3
    s_mul_i32 s71, s71, 7168
    s_add_u32 s40, s71, s53
    s_add_u32 s44, s71, s54
    s_add_u32 s71, s3, 1
    s_and_b32 s71, s71, 3
    s_mul_i32 s71, s71, 7168
    s_add_u32 s41, s71, s53
    s_add_u32 s45, s71, s54
    s_add_u32 s71, s3, 2
    s_and_b32 s71, s71, 3
    s_mul_i32 s71, s71, 7168
    s_add_u32 s42, s71, s53
    s_add_u32 s46, s71, s54
    s_add_u32 s71, s3, 3
    s_and_b32 s71, s71, 3
    s_mul_i32 s71, s71, 7168
    s_add_u32 s43, s71, s53
    s_add_u32 s47, s71, s54
    v_pk_mul_f32 v[42:43], v[64:65], v[64:65]
    v_pk_mul_f32 v[44:45], v[66:67], v[66:67]
    v_pk_mul_f32 v[46:47], v[68:69], v[68:69]
    v_pk_mul_f32 v[48:49], v[70:71], v[70:71]
    v_pk_fma_f32 v[42:43], v[42:43], s[72:73], v[60:61]
    v_pk_fma_f32 v[44:45], v[44:45], s[72:73], v[60:61]
    v_pk_fma_f32 v[46:47], v[46:47], s[72:73], v[60:61]
    v_pk_fma_f32 v[48:49], v[48:49], s[72:73], v[60:61]
    v_pk_mul_f32 v[42:43], v[42:43], v[64:65]
    v_pk_mul_f32 v[44:45], v[44:45], v[66:67]
    v_pk_mul_f32 v[46:47], v[46:47], v[68:69]
    v_pk_mul_f32 v[48:49], v[48:49], v[70:71]
    v_exp_f32 v42, v42
    v_exp_f32 v43, v43
    v_exp_f32 v44, v44
    v_exp_f32 v45, v45
    v_exp_f32 v46, v46
    v_exp_f32 v47, v47
    v_exp_f32 v48, v48
    v_exp_f32 v49, v49
    v_pk_add_f32 v[42:43], v[42:43], 1.0 op_sel_hi:[1,0]
    v_pk_add_f32 v[44:45], v[44:45], 1.0 op_sel_hi:[1,0]
    v_pk_add_f32 v[46:47], v[46:47], 1.0 op_sel_hi:[1,0]
    v_pk_add_f32 v[48:49], v[48:49], 1.0 op_sel_hi:[1,0]
    v_rcp_f32 v42, v42
    v_rcp_f32 v43, v43
    v_rcp_f32 v44, v44
    v_rcp_f32 v45, v45
    v_rcp_f32 v46, v46
    v_rcp_f32 v47, v47
    v_rcp_f32 v48, v48
    v_rcp_f32 v49, v49
    v_pk_mul_f32 v[42:43], v[42:43], v[64:65]
    v_pk_mul_f32 v[44:45], v[44:45], v[66:67]
    v_pk_mul_f32 v[46:47], v[46:47], v[68:69]
    v_pk_mul_f32 v[48:49], v[48:49], v[70:71]
    v_cvt_pk_bf16_f32 v52, v42, v43
    v_cvt_pk_bf16_f32 v53, v44, v45
    v_cvt_pk_bf16_f32 v54, v46, v47
    v_cvt_pk_bf16_f32 v55, v48, v49
    buffer_store_dwordx4 v[52:55], v5, s[8:11], s52 offen offset:0 sc1
    v_pk_mul_f32 v[42:43], v[72:73], v[72:73]
    v_pk_mul_f32 v[44:45], v[74:75], v[74:75]
    v_pk_mul_f32 v[46:47], v[76:77], v[76:77]
    v_pk_mul_f32 v[48:49], v[78:79], v[78:79]
    v_pk_fma_f32 v[42:43], v[42:43], s[72:73], v[60:61]
    v_pk_fma_f32 v[44:45], v[44:45], s[72:73], v[60:61]
    v_pk_fma_f32 v[46:47], v[46:47], s[72:73], v[60:61]
    v_pk_fma_f32 v[48:49], v[48:49], s[72:73], v[60:61]
    v_pk_mul_f32 v[42:43], v[42:43], v[72:73]
    v_pk_mul_f32 v[44:45], v[44:45], v[74:75]
    v_pk_mul_f32 v[46:47], v[46:47], v[76:77]
    v_pk_mul_f32 v[48:49], v[48:49], v[78:79]
    v_exp_f32 v42, v42
    v_exp_f32 v43, v43
    v_exp_f32 v44, v44
    v_exp_f32 v45, v45
    v_exp_f32 v46, v46
    v_exp_f32 v47, v47
    v_exp_f32 v48, v48
    v_exp_f32 v49, v49
    v_pk_add_f32 v[42:43], v[42:43], 1.0 op_sel_hi:[1,0]
    v_pk_add_f32 v[44:45], v[44:45], 1.0 op_sel_hi:[1,0]
    v_pk_add_f32 v[46:47], v[46:47], 1.0 op_sel_hi:[1,0]
    v_pk_add_f32 v[48:49], v[48:49], 1.0 op_sel_hi:[1,0]
    v_rcp_f32 v42, v42
    v_rcp_f32 v43, v43
    v_rcp_f32 v44, v44
    v_rcp_f32 v45, v45
    v_rcp_f32 v46, v46
    v_rcp_f32 v47, v47
    v_rcp_f32 v48, v48
    v_rcp_f32 v49, v49
    v_pk_mul_f32 v[42:43], v[42:43], v[72:73]
    v_pk_mul_f32 v[44:45], v[44:45], v[74:75]
    v_pk_mul_f32 v[46:47], v[46:47], v[76:77]
    v_pk_mul_f32 v[48:49], v[48:49], v[78:79]
    v_cvt_pk_bf16_f32 v56, v42, v43
    v_cvt_pk_bf16_f32 v57, v44, v45
    v_cvt_pk_bf16_f32 v58, v46, v47
    v_cvt_pk_bf16_f32 v59, v48, v49
    buffer_store_dwordx4 v[56:59], v5, s[8:11], s52 offen offset:1024 sc1
    v_pk_mul_f32 v[42:43], v[80:81], v[80:81]
    v_pk_mul_f32 v[44:45], v[82:83], v[82:83]
    v_pk_mul_f32 v[46:47], v[84:85], v[84:85]
    v_pk_mul_f32 v[48:49], v[86:87], v[86:87]
    v_pk_fma_f32 v[42:43], v[42:43], s[72:73], v[60:61]
    v_pk_fma_f32 v[44:45], v[44:45], s[72:73], v[60:61]
    v_pk_fma_f32 v[46:47], v[46:47], s[72:73], v[60:61]
    v_pk_fma_f32 v[48:49], v[48:49], s[72:73], v[60:61]
    v_pk_mul_f32 v[42:43], v[42:43], v[80:81]
    v_pk_mul_f32 v[44:45], v[44:45], v[82:83]
    v_pk_mul_f32 v[46:47], v[46:47], v[84:85]
    v_pk_mul_f32 v[48:49], v[48:49], v[86:87]
    v_exp_f32 v42, v42
    v_exp_f32 v43, v43
    v_exp_f32 v44, v44
    v_exp_f32 v45, v45
    v_exp_f32 v46, v46
    v_exp_f32 v47, v47
    v_exp_f32 v48, v48
    v_exp_f32 v49, v49
    v_pk_add_f32 v[42:43], v[42:43], 1.0 op_sel_hi:[1,0]
    v_pk_add_f32 v[44:45], v[44:45], 1.0 op_sel_hi:[1,0]
    v_pk_add_f32 v[46:47], v[46:47], 1.0 op_sel_hi:[1,0]
    v_pk_add_f32 v[48:49], v[48:49], 1.0 op_sel_hi:[1,0]
    v_rcp_f32 v42, v42
    v_rcp_f32 v43, v43
    v_rcp_f32 v44, v44
    v_rcp_f32 v45, v45
    v_rcp_f32 v46, v46
    v_rcp_f32 v47, v47
    v_rcp_f32 v48, v48
    v_rcp_f32 v49, v49
    v_pk_mul_f32 v[42:43], v[42:43], v[80:81]
    v_pk_mul_f32 v[44:45], v[44:45], v[82:83]
    v_pk_mul_f32 v[46:47], v[46:47], v[84:85]
    v_pk_mul_f32 v[48:49], v[48:49], v[86:87]
    v_cvt_pk_bf16_f32 v52, v42, v43
    v_cvt_pk_bf16_f32 v53, v44, v45
    v_cvt_pk_bf16_f32 v54, v46, v47
    v_cvt_pk_bf16_f32 v55, v48, v49
    buffer_store_dwordx4 v[52:55], v5, s[8:11], s52 offen offset:2048 sc1
    v_pk_mul_f32 v[42:43], v[88:89], v[88:89]
    v_pk_mul_f32 v[44:45], v[90:91], v[90:91]
    v_pk_mul_f32 v[46:47], v[92:93], v[92:93]
    v_pk_mul_f32 v[48:49], v[94:95], v[94:95]
    v_pk_fma_f32 v[42:43], v[42:43], s[72:73], v[60:61]
    v_pk_fma_f32 v[44:45], v[44:45], s[72:73], v[60:61]
    v_pk_fma_f32 v[46:47], v[46:47], s[72:73], v[60:61]
    v_pk_fma_f32 v[48:49], v[48:49], s[72:73], v[60:61]
    v_pk_mul_f32 v[42:43], v[42:43], v[88:89]
    v_pk_mul_f32 v[44:45], v[44:45], v[90:91]
    v_pk_mul_f32 v[46:47], v[46:47], v[92:93]
    v_pk_mul_f32 v[48:49], v[48:49], v[94:95]
    v_exp_f32 v42, v42
    v_exp_f32 v43, v43
    v_exp_f32 v44, v44
    v_exp_f32 v45, v45
    v_exp_f32 v46, v46
    v_exp_f32 v47, v47
    v_exp_f32 v48, v48
    v_exp_f32 v49, v49
    v_pk_add_f32 v[42:43], v[42:43], 1.0 op_sel_hi:[1,0]
    v_pk_add_f32 v[44:45], v[44:45], 1.0 op_sel_hi:[1,0]
    v_pk_add_f32 v[46:47], v[46:47], 1.0 op_sel_hi:[1,0]
    v_pk_add_f32 v[48:49], v[48:49], 1.0 op_sel_hi:[1,0]
    v_rcp_f32 v42, v42
    v_rcp_f32 v43, v43
    v_rcp_f32 v44, v44
    v_rcp_f32 v45, v45
    v_rcp_f32 v46, v46
    v_rcp_f32 v47, v47
    v_rcp_f32 v48, v48
    v_rcp_f32 v49, v49
    v_pk_mul_f32 v[42:43], v[42:43], v[88:89]
    v_pk_mul_f32 v[44:45], v[44:45], v[90:91]
    v_pk_mul_f32 v[46:47], v[46:47], v[92:93]
    v_pk_mul_f32 v[48:49], v[48:49], v[94:95]
    v_cvt_pk_bf16_f32 v56, v42, v43
    v_cvt_pk_bf16_f32 v57, v44, v45
    v_cvt_pk_bf16_f32 v58, v46, v47
    v_cvt_pk_bf16_f32 v59, v48, v49
    buffer_store_dwordx4 v[56:59], v5, s[8:11], s52 offen offset:3072 sc1
    s_waitcnt lgkmcnt(6)
    v_mfma_f32_32x32x16_bf16 v[96:111], v[32:35], v[140:143], v[96:111]
    ds_read_b64_tr_b16 v[28:29], v14 offset:18688
    ds_read_b64_tr_b16 v[30:31], v14 offset:19584
    v_mfma_f32_32x32x16_bf16 v[112:127], v[36:39], v[140:143], v[112:127]
    ds_read_b64_tr_b16 v[32:33], v6 offset:22016
    ds_read_b64_tr_b16 v[34:35], v6 offset:22912
    s_waitcnt lgkmcnt(6)
    v_mfma_f32_32x32x16_bf16 v[96:111], v[16:19], v[144:147], v[96:111]
    ds_read_b64_tr_b16 v[36:37], v14 offset:22272
    ds_read_b64_tr_b16 v[38:39], v14 offset:23168
    ds_read_b64_tr_b16 a[160:161], v11 offset:0
    ds_read_b64_tr_b16 a[162:163], v11 offset:1024
    ds_read_b64_tr_b16 a[164:165], v11 offset:256
    ds_read_b64_tr_b16 a[166:167], v11 offset:1280
    v_mfma_f32_32x32x16_bf16 v[112:127], v[20:23], v[144:147], v[112:127]
    ds_read_b64_tr_b16 v[16:17], v6 offset:25600
    ds_read_b64_tr_b16 v[18:19], v6 offset:26496
    ds_read_b64_tr_b16 a[168:169], v11 offset:2048
    ds_read_b64_tr_b16 a[170:171], v11 offset:3072
    ds_read_b64_tr_b16 a[172:173], v11 offset:2304
    ds_read_b64_tr_b16 a[174:175], v11 offset:3328
    s_waitcnt lgkmcnt(14)
    v_mfma_f32_32x32x16_bf16 v[96:111], v[24:27], v[148:151], v[96:111]
    ds_read_b64_tr_b16 v[20:21], v14 offset:25856
    ds_read_b64_tr_b16 v[22:23], v14 offset:26752
    ds_read_b64_tr_b16 a[176:177], v11 offset:4096
    ds_read_b64_tr_b16 a[178:179], v11 offset:5120
    ds_read_b64_tr_b16 a[180:181], v11 offset:4352
    ds_read_b64_tr_b16 a[182:183], v11 offset:5376
    v_mfma_f32_32x32x16_bf16 v[112:127], v[28:31], v[148:151], v[112:127]
    ds_read_b64_tr_b16 v[24:25], v6 offset:29184
    ds_read_b64_tr_b16 v[26:27], v6 offset:30080
    ds_read_b64_tr_b16 a[184:185], v11 offset:6144
    ds_read_b64_tr_b16 a[186:187], v11 offset:7168
    ds_read_b64_tr_b16 a[188:189], v11 offset:6400
    ds_read_b64_tr_b16 a[190:191], v11 offset:7424
    s_waitcnt lgkmcnt(15)
    v_mfma_f32_32x32x16_bf16 v[96:111], v[32:35], v[152:155], v[96:111]
    ds_read_b64_tr_b16 v[28:29], v14 offset:29440
    ds_read_b64_tr_b16 v[30:31], v14 offset:30336
    s_add_u32 m0, s100, 0
    s_add_u32 s74, s27, 49152
    buffer_load_dwordx4 v10, s[16:19], s74 offen lds
    v_mfma_f32_32x32x16_bf16 v[112:127], v[36:39], v[152:155], v[112:127]
    ds_read_b64_tr_b16 v[32:33], v6 offset:32768
    ds_read_b64_tr_b16 v[34:35], v6 offset:33664
    s_add_u32 m0, s100, 1024
    s_add_u32 s74, s27, 57344
    buffer_load_dwordx4 v10, s[16:19], s74 offen lds
    s_waitcnt lgkmcnt(14)
    v_mfma_f32_32x32x16_bf16 v[96:111], v[16:19], v[156:159], v[96:111]
    ds_read_b64_tr_b16 v[36:37], v14 offset:33024
    ds_read_b64_tr_b16 v[38:39], v14 offset:33920
    s_add_u32 m0, s100, 2048
    s_add_u32 s74, s27, 65536
    buffer_load_dwordx4 v10, s[16:19], s74 offen lds
    v_mfma_f32_32x32x16_bf16 v[112:127], v[20:23], v[156:159], v[112:127]
    ds_read_b64_tr_b16 v[16:17], v6 offset:36352
    ds_read_b64_tr_b16 v[18:19], v6 offset:37248
    s_add_u32 m0, s100, 3072
    s_add_u32 s74, s27, 73728
    buffer_load_dwordx4 v10, s[16:19], s74 offen lds
    s_waitcnt lgkmcnt(6)
    v_mfma_f32_32x32x16_bf16 v[96:111], v[24:27], v[160:163], v[96:111]
    ds_read_b64_tr_b16 v[20:21], v14 offset:36608
    ds_read_b64_tr_b16 v[22:23], v14 offset:37504
    s_add_u32 m0, s100, 4096
    s_add_u32 s74, s27, 81920
    buffer_load_dwordx4 v10, s[16:19], s74 offen lds
    v_mfma_f32_32x32x16_bf16 v[112:127], v[28:31], v[160:163], v[112:127]
    ds_read_b64_tr_b16 v[24:25], v6 offset:39936
    ds_read_b64_tr_b16 v[26:27], v6 offset:40832
    s_add_u32 m0, s100, 5120
    s_add_u32 s74, s27, 90112
    buffer_load_dwordx4 v10, s[16:19], s74 offen lds
    s_waitcnt lgkmcnt(6)
    v_mfma_f32_32x32x16_bf16 v[96:111], v[32:35], v[164:167], v[96:111]
    ds_read_b64_tr_b16 v[28:29], v14 offset:40192
    ds_read_b64_tr_b16 v[30:31], v14 offset:41088
    s_add_u32 m0, s100, 6144
    s_add_u32 s74, s27, 98304
    buffer_load_dwordx4 v10, s[16:19], s74 offen lds
    v_mfma_f32_32x32x16_bf16 v[112:127], v[36:39], v[164:167], v[112:127]
    ds_read_b64_tr_b16 v[32:33], v6 offset:43520
    ds_read_b64_tr_b16 v[34:35], v6 offset:44416
    s_add_u32 m0, s100, 7168
    s_add_u32 s74, s27, 106496
    buffer_load_dwordx4 v10, s[16:19], s74 offen lds
    s_waitcnt lgkmcnt(6)
    v_mfma_f32_32x32x16_bf16 v[96:111], v[16:19], v[168:171], v[96:111]
    ds_read_b64_tr_b16 v[36:37], v14 offset:43776
    ds_read_b64_tr_b16 v[38:39], v14 offset:44672
    v_mfma_f32_32x32x16_bf16 v[112:127], v[20:23], v[168:171], v[112:127]
    ds_read_b64_tr_b16 v[16:17], v6 offset:47104
    ds_read_b64_tr_b16 v[18:19], v6 offset:48000
    s_waitcnt lgkmcnt(6)
    v_mfma_f32_32x32x16_bf16 v[96:111], v[24:27], v[172:175], v[96:111]
    ds_read_b64_tr_b16 v[20:21], v14 offset:47360
    ds_read_b64_tr_b16 v[22:23], v14 offset:48256
    v_mfma_f32_32x32x16_bf16 v[112:127], v[28:31], v[172:175], v[112:127]
    ds_read_b64_tr_b16 v[24:25], v6 offset:50688
    ds_read_b64_tr_b16 v[26:27], v6 offset:51584
    s_waitcnt lgkmcnt(6)
    v_mfma_f32_32x32x16_bf16 v[96:111], v[32:35], v[176:179], v[96:111]
    ds_read_b64_tr_b16 v[28:29], v14 offset:50944
    ds_read_b64_tr_b16 v[30:31], v14 offset:51840
    v_mfma_f32_32x32x16_bf16 v[112:127], v[36:39], v[176:179], v[112:127]
    ds_read_b64_tr_b16 v[32:33], v6 offset:54272
    ds_read_b64_tr_b16 v[34:35], v6 offset:55168
    s_waitcnt lgkmcnt(6)
    v_mfma_f32_32x32x16_bf16 v[96:111], v[16:19], v[180:183], v[96:111]
    ds_read_b64_tr_b16 v[36:37], v14 offset:54528
    ds_read_b64_tr_b16 v[38:39], v14 offset:55424
    v_mfma_f32_32x32x16_bf16 v[112:127], v[20:23], v[180:183], v[112:127]
    ds_read_b64_tr_b16 v[16:17], v7 offset:512
    ds_read_b64_tr_b16 v[18:19], v7 offset:1408
    s_waitcnt lgkmcnt(6)
    v_mfma_f32_32x32x16_bf16 v[96:111], v[24:27], v[184:187], v[96:111]
    ds_read_b64_tr_b16 v[20:21], v15 offset:768
    ds_read_b64_tr_b16 v[22:23], v15 offset:1664
    v_mfma_f32_32x32x16_bf16 v[112:127], v[28:31], v[184:187], v[112:127]
    ds_read_b64_tr_b16 v[24:25], v7 offset:4096
    ds_read_b64_tr_b16 v[26:27], v7 offset:4992
    s_waitcnt lgkmcnt(6)
    v_mfma_f32_32x32x16_bf16 v[96:111], v[32:35], v[188:191], v[96:111]
    ds_read_b64_tr_b16 v[28:29], v15 offset:4352
    ds_read_b64_tr_b16 v[30:31], v15 offset:5248
    v_mfma_f32_32x32x16_bf16 v[112:127], v[36:39], v[188:191], v[112:127]
    ds_read_b64_tr_b16 v[32:33], v7 offset:7680
    ds_read_b64_tr_b16 v[34:35], v7 offset:8576
    s_waitcnt lgkmcnt(6)
    v_mfma_f32_32x32x16_bf16 v[96:111], v[16:19], v[192:195], v[96:111]
    ds_read_b64_tr_b16 v[36:37], v15 offset:7936
    ds_read_b64_tr_b16 v[38:39], v15 offset:8832
    v_mfma_f32_32x32x16_bf16 v[112:127], v[20:23], v[192:195], v[112:127]
    ds_read_b64_tr_b16 v[16:17], v7 offset:11264
    ds_read_b64_tr_b16 v[18:19], v7 offset:12160
    s_waitcnt lgkmcnt(6)
    v_mfma_f32_32x32x16_bf16 v[96:111], v[24:27], v[196:199], v[96:111]
    ds_read_b64_tr_b16 v[20:21], v15 offset:11520
    ds_read_b64_tr_b16 v[22:23], v15 offset:12416
    s_add_u32 s70, s40, 0
    buffer_load_dwordx4 v[128:131], v5, s[8:11], s70 offen sc1
    v_mfma_f32_32x32x16_bf16 v[112:127], v[28:31], v[196:199], v[112:127]
    ds_read_b64_tr_b16 v[24:25], v7 offset:14848
    ds_read_b64_tr_b16 v[26:27], v7 offset:15744
    s_add_u32 s70, s44, 0
    buffer_load_dwordx4 v[132:135], v5, s[8:11], s70 offen sc1
    s_waitcnt lgkmcnt(6)
    v_mfma_f32_32x32x16_bf16 v[96:111], v[32:35], v[200:203], v[96:111]
    ds_read_b64_tr_b16 v[28:29], v15 offset:15104
    ds_read_b64_tr_b16 v[30:31], v15 offset:16000
    s_add_u32 s70, s41, 0
    buffer_load_dwordx4 v[136:139], v5, s[8:11], s70 offen sc1
    v_mfma_f32_32x32x16_bf16 v[112:127], v[36:39], v[200:203], v[112:127]
    ds_read_b64_tr_b16 v[32:33], v7 offset:18432
    ds_read_b64_tr_b16 v[34:35], v7 offset:19328
    s_add_u32 s70, s45, 0
    buffer_load_dwordx4 v[140:143], v5, s[8:11], s70 offen sc1
    s_waitcnt lgkmcnt(6)
    v_mfma_f32_32x32x16_bf16 v[96:111], v[16:19], v[204:207], v[96:111]
    ds_read_b64_tr_b16 v[36:37], v15 offset:18688
    ds_read_b64_tr_b16 v[38:39], v15 offset:19584
    s_add_u32 s70, s42, 0
    buffer_load_dwordx4 v[144:147], v5, s[8:11], s70 offen sc1
    v_mfma_f32_32x32x16_bf16 v[112:127], v[20:23], v[204:207], v[112:127]
    ds_read_b64_tr_b16 v[16:17], v7 offset:22016
    ds_read_b64_tr_b16 v[18:19], v7 offset:22912
    s_add_u32 s70, s46, 0
    buffer_load_dwordx4 v[148:151], v5, s[8:11], s70 offen sc1
    s_waitcnt lgkmcnt(6)
    v_mfma_f32_32x32x16_bf16 v[96:111], v[24:27], v[208:211], v[96:111]
    ds_read_b64_tr_b16 v[20:21], v15 offset:22272
    ds_read_b64_tr_b16 v[22:23], v15 offset:23168
    s_add_u32 s70, s43, 0
    buffer_load_dwordx4 v[152:155], v5, s[8:11], s70 offen sc1
    v_mfma_f32_32x32x16_bf16 v[112:127], v[28:31], v[208:211], v[112:127]
    ds_read_b64_tr_b16 v[24:25], v7 offset:25600
    ds_read_b64_tr_b16 v[26:27], v7 offset:26496
    s_add_u32 s70, s47, 0
    buffer_load_dwordx4 v[156:159], v5, s[8:11], s70 offen sc1
    s_waitcnt lgkmcnt(6)
    v_mfma_f32_32x32x16_bf16 v[96:111], v[32:35], v[212:215], v[96:111]
    ds_read_b64_tr_b16 v[28:29], v15 offset:25856
    ds_read_b64_tr_b16 v[30:31], v15 offset:26752
    s_add_u32 s70, s40, 1024
    buffer_load_dwordx4 v[160:163], v5, s[8:11], s70 offen sc1
    v_mfma_f32_32x32x16_bf16 v[112:127], v[36:39], v[212:215], v[112:127]
    ds_read_b64_tr_b16 v[32:33], v7 offset:29184
    ds_read_b64_tr_b16 v[34:35], v7 offset:30080
    s_add_u32 s70, s44, 1024
    buffer_load_dwordx4 v[164:167], v5, s[8:11], s70 offen sc1
    s_waitcnt lgkmcnt(6)
    v_mfma_f32_32x32x16_bf16 v[96:111], v[16:19], v[216:219], v[96:111]
    ds_read_b64_tr_b16 v[36:37], v15 offset:29440
    ds_read_b64_tr_b16 v[38:39], v15 offset:30336
    s_add_u32 s70, s41, 1024
    buffer_load_dwordx4 v[168:171], v5, s[8:11], s70 offen sc1
    v_mfma_f32_32x32x16_bf16 v[112:127], v[20:23], v[216:219], v[112:127]
    ds_read_b64_tr_b16 v[16:17], v7 offset:32768
    ds_read_b64_tr_b16 v[18:19], v7 offset:33664
    s_add_u32 s70, s45, 1024
    buffer_load_dwordx4 v[172:175], v5, s[8:11], s70 offen sc1
    s_waitcnt lgkmcnt(6)
    v_mfma_f32_32x32x16_bf16 v[96:111], v[24:27], v[220:223], v[96:111]
    ds_read_b64_tr_b16 v[20:21], v15 offset:33024
    ds_read_b64_tr_b16 v[22:23], v15 offset:33920
    s_add_u32 s70, s42, 1024
    buffer_load_dwordx4 v[176:179], v5, s[8:11], s70 offen sc1
    v_mfma_f32_32x32x16_bf16 v[112:127], v[28:31], v[220:223], v[112:127]
    ds_read_b64_tr_b16 v[24:25], v7 offset:36352
    ds_read_b64_tr_b16 v[26:27], v7 offset:37248
    s_add_u32 s70, s46, 1024
    buffer_load_dwordx4 v[180:183], v5, s[8:11], s70 offen sc1
    s_waitcnt lgkmcnt(6)
    v_mfma_f32_32x32x16_bf16 v[96:111], v[32:35], v[224:227], v[96:111]
    ds_read_b64_tr_b16 v[28:29], v15 offset:36608
    ds_read_b64_tr_b16 v[30:31], v15 offset:37504
    s_add_u32 s70, s43, 1024
    buffer_load_dwordx4 v[184:187], v5, s[8:11], s70 offen sc1
    v_mfma_f32_32x32x16_bf16 v[112:127], v[36:39], v[224:227], v[112:127]
    ds_read_b64_tr_b16 v[32:33], v7 offset:39936
    ds_read_b64_tr_b16 v[34:35], v7 offset:40832
    s_add_u32 s70, s47, 1024
    buffer_load_dwordx4 v[188:191], v5, s[8:11], s70 offen sc1
    s_waitcnt lgkmcnt(6)
    v_mfma_f32_32x32x16_bf16 v[96:111], v[16:19], v[228:231], v[96:111]
    ds_read_b64_tr_b16 v[36:37], v15 offset:40192
    ds_read_b64_tr_b16 v[38:39], v15 offset:41088
    v_mfma_f32_32x32x16_bf16 v[112:127], v[20:23], v[228:231], v[112:127]
    ds_read_b64_tr_b16 v[16:17], v7 offset:43520
    ds_read_b64_tr_b16 v[18:19], v7 offset:44416
    s_waitcnt lgkmcnt(6)
    v_mfma_f32_32x32x16_bf16 v[96:111], v[24:27], v[232:235], v[96:111]
    ds_read_b64_tr_b16 v[20:21], v15 offset:43776
    ds_read_b64_tr_b16 v[22:23], v15 offset:44672
    v_mfma_f32_32x32x16_bf16 v[112:127], v[28:31], v[232:235], v[112:127]
    ds_read_b64_tr_b16 v[24:25], v7 offset:47104
    ds_read_b64_tr_b16 v[26:27], v7 offset:48000
    s_waitcnt lgkmcnt(6)
    v_mfma_f32_32x32x16_bf16 v[96:111], v[32:35], v[236:239], v[96:111]
    ds_read_b64_tr_b16 v[28:29], v15 offset:47360
    ds_read_b64_tr_b16 v[30:31], v15 offset:48256
    v_mfma_f32_32x32x16_bf16 v[112:127], v[36:39], v[236:239], v[112:127]
    ds_read_b64_tr_b16 v[32:33], v7 offset:50688
    ds_read_b64_tr_b16 v[34:35], v7 offset:51584
    s_waitcnt lgkmcnt(6)
    v_mfma_f32_32x32x16_bf16 v[96:111], v[16:19], v[240:243], v[96:111]
    ds_read_b64_tr_b16 v[36:37], v15 offset:50944
    ds_read_b64_tr_b16 v[38:39], v15 offset:51840
    v_mfma_f32_32x32x16_bf16 v[112:127], v[20:23], v[240:243], v[112:127]
    ds_read_b64_tr_b16 v[16:17], v7 offset:54272
    ds_read_b64_tr_b16 v[18:19], v7 offset:55168
    s_waitcnt lgkmcnt(6)
    v_mfma_f32_32x32x16_bf16 v[96:111], v[24:27], v[244:247], v[96:111]
    ds_read_b64_tr_b16 v[20:21], v15 offset:54528
    ds_read_b64_tr_b16 v[22:23], v15 offset:55424
    v_mfma_f32_32x32x16_bf16 v[112:127], v[28:31], v[244:247], v[112:127]
    s_waitcnt lgkmcnt(4)
    v_mfma_f32_32x32x16_bf16 v[96:111], v[32:35], v[248:251], v[96:111]
    v_mfma_f32_32x32x16_bf16 v[112:127], v[36:39], v[248:251], v[112:127]
    s_waitcnt lgkmcnt(0)
    v_mfma_f32_32x32x16_bf16 v[96:111], v[16:19], v[252:255], v[96:111]
    v_mfma_f32_32x32x16_bf16 v[112:127], v[20:23], v[252:255], v[112:127]
    s_nop 7
    s_nop 2
    v_pk_mul_f32 v[42:43], v[96:97], v[96:97]
    v_pk_mul_f32 v[44:45], v[98:99], v[98:99]
    v_pk_mul_f32 v[46:47], v[100:101], v[100:101]
    v_pk_mul_f32 v[48:49], v[102:103], v[102:103]
    v_pk_fma_f32 v[42:43], v[42:43], s[72:73], v[60:61]
    v_pk_fma_f32 v[44:45], v[44:45], s[72:73], v[60:61]
    v_pk_fma_f32 v[46:47], v[46:47], s[72:73], v[60:61]
    v_pk_fma_f32 v[48:49], v[48:49], s[72:73], v[60:61]
    v_pk_mul_f32 v[42:43], v[42:43], v[96:97]
    v_pk_mul_f32 v[44:45], v[44:45], v[98:99]
    s_add_u32 s70, s40, 2048
    buffer_load_dwordx4 v[192:195], v5, s[8:11], s70 offen sc1
    v_pk_mul_f32 v[46:47], v[46:47], v[100:101]
    v_pk_mul_f32 v[48:49], v[48:49], v[102:103]
    v_exp_f32 v42, v42
    v_exp_f32 v43, v43
    v_exp_f32 v44, v44
    v_exp_f32 v45, v45
    v_exp_f32 v46, v46
    v_exp_f32 v47, v47
    v_exp_f32 v48, v48
    v_exp_f32 v49, v49
    v_pk_add_f32 v[42:43], v[42:43], 1.0 op_sel_hi:[1,0]
    s_add_u32 s70, s44, 2048
    buffer_load_dwordx4 v[196:199], v5, s[8:11], s70 offen sc1
    v_pk_add_f32 v[44:45], v[44:45], 1.0 op_sel_hi:[1,0]
    v_pk_add_f32 v[46:47], v[46:47], 1.0 op_sel_hi:[1,0]
    v_pk_add_f32 v[48:49], v[48:49], 1.0 op_sel_hi:[1,0]
    v_rcp_f32 v42, v42
    v_rcp_f32 v43, v43
    v_rcp_f32 v44, v44
    v_rcp_f32 v45, v45
    v_rcp_f32 v46, v46
    v_rcp_f32 v47, v47
    v_rcp_f32 v48, v48
    v_rcp_f32 v49, v49
    s_add_u32 s70, s41, 2048
    buffer_load_dwordx4 v[200:203], v5, s[8:11], s70 offen sc1
    v_pk_mul_f32 v[42:43], v[42:43], v[96:97]
    v_pk_mul_f32 v[44:45], v[44:45], v[98:99]
    v_pk_mul_f32 v[46:47], v[46:47], v[100:101]
    v_pk_mul_f32 v[48:49], v[48:49], v[102:103]
    v_cvt_pk_bf16_f32 v52, v42, v43
    v_cvt_pk_bf16_f32 v53, v44, v45
    v_cvt_pk_bf16_f32 v54, v46, v47
    v_cvt_pk_bf16_f32 v55, v48, v49
    buffer_store_dwordx4 v[52:55], v5, s[8:11], s58 offen offset:0 sc1
    v_pk_mul_f32 v[42:43], v[104:105], v[104:105]
    v_pk_mul_f32 v[44:45], v[106:107], v[106:107]
    s_add_u32 s70, s45, 2048
    buffer_load_dwordx4 v[204:207], v5, s[8:11], s70 offen sc1
    v_pk_mul_f32 v[46:47], v[108:109], v[108:109]
    v_pk_mul_f32 v[48:49], v[110:111], v[110:111]
    v_pk_fma_f32 v[42:43], v[42:43], s[72:73], v[60:61]
    v_pk_fma_f32 v[44:45], v[44:45], s[72:73], v[60:61]
    v_pk_fma_f32 v[46:47], v[46:47], s[72:73], v[60:61]
    v_pk_fma_f32 v[48:49], v[48:49], s[72:73], v[60:61]
    v_pk_mul_f32 v[42:43], v[42:43], v[104:105]
    v_pk_mul_f32 v[44:45], v[44:45], v[106:107]
    v_pk_mul_f32 v[46:47], v[46:47], v[108:109]
    v_pk_mul_f32 v[48:49], v[48:49], v[110:111]
    v_exp_f32 v42, v42
    s_add_u32 s70, s42, 2048
    buffer_load_dwordx4 v[208:211], v5, s[8:11], s70 offen sc1
    v_exp_f32 v43, v43
    v_exp_f32 v44, v44
    v_exp_f32 v45, v45
    v_exp_f32 v46, v46
    v_exp_f32 v47, v47
    v_exp_f32 v48, v48
    v_exp_f32 v49, v49
    v_pk_add_f32 v[42:43], v[42:43], 1.0 op_sel_hi:[1,0]
    v_pk_add_f32 v[44:45], v[44:45], 1.0 op_sel_hi:[1,0]
    v_pk_add_f32 v[46:47], v[46:47], 1.0 op_sel_hi:[1,0]
    v_pk_add_f32 v[48:49], v[48:49], 1.0 op_sel_hi:[1,0]
    s_add_u32 s70, s46, 2048
    buffer_load_dwordx4 v[212:215], v5, s[8:11], s70 offen sc1
    v_rcp_f32 v42, v42
    v_rcp_f32 v43, v43
    v_rcp_f32 v44, v44
    v_rcp_f32 v45, v45
    v_rcp_f32 v46, v46
    v_rcp_f32 v47, v47
    v_rcp_f32 v48, v48
    v_rcp_f32 v49, v49
    v_pk_mul_f32 v[42:43], v[42:43], v[104:105]
    v_pk_mul_f32 v[44:45], v[44:45], v[106:107]
    v_pk_mul_f32 v[46:47], v[46:47], v[108:109]
    s_add_u32 s70, s43, 2048
    buffer_load_dwordx4 v[216:219], v5, s[8:11], s70 offen sc1
    v_pk_mul_f32 v[48:49], v[48:49], v[110:111]
    v_cvt_pk_bf16_f32 v56, v42, v43
    v_cvt_pk_bf16_f32 v57, v44, v45
    v_cvt_pk_bf16_f32 v58, v46, v47
    v_cvt_pk_bf16_f32 v59, v48, v49
    buffer_store_dwordx4 v[56:59], v5, s[8:11], s58 offen offset:1024 sc1
    v_pk_mul_f32 v[42:43], v[112:113], v[112:113]
    v_pk_mul_f32 v[44:45], v[114:115], v[114:115]
    v_pk_mul_f32 v[46:47], v[116:117], v[116:117]
    v_pk_mul_f32 v[48:49], v[118:119], v[118:119]
    v_pk_fma_f32 v[42:43], v[42:43], s[72:73], v[60:61]
    s_add_u32 s70, s47, 2048
    buffer_load_dwordx4 v[220:223], v5, s[8:11], s70 offen sc1
    v_pk_fma_f32 v[44:45], v[44:45], s[72:73], v[60:61]
    v_pk_fma_f32 v[46:47], v[46:47], s[72:73], v[60:61]
    v_pk_fma_f32 v[48:49], v[48:49], s[72:73], v[60:61]
    v_pk_mul_f32 v[42:43], v[42:43], v[112:113]
    v_pk_mul_f32 v[44:45], v[44:45], v[114:115]
    v_pk_mul_f32 v[46:47], v[46:47], v[116:117]
    v_pk_mul_f32 v[48:49], v[48:49], v[118:119]
    v_exp_f32 v42, v42
    v_exp_f32 v43, v43
    v_exp_f32 v44, v44
    v_exp_f32 v45, v45
    v_exp_f32 v46, v46
    v_exp_f32 v47, v47
    v_exp_f32 v48, v48
    v_exp_f32 v49, v49
    v_pk_add_f32 v[42:43], v[42:43], 1.0 op_sel_hi:[1,0]
    v_pk_add_f32 v[44:45], v[44:45], 1.0 op_sel_hi:[1,0]
    v_pk_add_f32 v[46:47], v[46:47], 1.0 op_sel_hi:[1,0]
    v_pk_add_f32 v[48:49], v[48:49], 1.0 op_sel_hi:[1,0]
    v_rcp_f32 v42, v42
    v_rcp_f32 v43, v43
    v_rcp_f32 v44, v44
    v_rcp_f32 v45, v45
    v_rcp_f32 v46, v46
    v_rcp_f32 v47, v47
    v_rcp_f32 v48, v48
    v_rcp_f32 v49, v49
    v_pk_mul_f32 v[42:43], v[42:43], v[112:113]
    v_pk_mul_f32 v[44:45], v[44:45], v[114:115]
    v_pk_mul_f32 v[46:47], v[46:47], v[116:117]
    v_pk_mul_f32 v[48:49], v[48:49], v[118:119]
    v_cvt_pk_bf16_f32 v52, v42, v43
    v_cvt_pk_bf16_f32 v53, v44, v45
    v_cvt_pk_bf16_f32 v54, v46, v47
    v_cvt_pk_bf16_f32 v55, v48, v49
    buffer_store_dwordx4 v[52:55], v5, s[8:11], s58 offen offset:2048 sc1
    s_waitcnt vmcnt(33)
    ds_read_b64_tr_b16 a[192:193], v11 offset:0
    ds_read_b64_tr_b16 a[194:195], v11 offset:1024
    ds_read_b64_tr_b16 a[196:197], v11 offset:256
    ds_read_b64_tr_b16 a[198:199], v11 offset:1280
    s_waitcnt vmcnt(31)
    ds_read_b64_tr_b16 a[200:201], v11 offset:2048
    ds_read_b64_tr_b16 a[202:203], v11 offset:3072
    ds_read_b64_tr_b16 a[204:205], v11 offset:2304
    ds_read_b64_tr_b16 a[206:207], v11 offset:3328
    s_waitcnt vmcnt(29)
    ds_read_b64_tr_b16 a[208:209], v11 offset:4096
    ds_read_b64_tr_b16 a[210:211], v11 offset:5120
    ds_read_b64_tr_b16 a[212:213], v11 offset:4352
    ds_read_b64_tr_b16 a[214:215], v11 offset:5376
    s_waitcnt vmcnt(27)
    ds_read_b64_tr_b16 a[216:217], v11 offset:6144
    ds_read_b64_tr_b16 a[218:219], v11 offset:7168
    ds_read_b64_tr_b16 a[220:221], v11 offset:6400
    ds_read_b64_tr_b16 a[222:223], v11 offset:7424
    s_waitcnt vmcnt(23) lgkmcnt(0)
    v_max3_u32 v12, v128, v129, v130
    v_max3_u32 v12, v12, v131, v132
    v_max3_u32 v12, v12, v133, v134
    v_max3_u32 v12, v12, v135, v136
    v_max3_u32 v12, v12, v137, v138
    v_max3_u32 v12, v12, v139, v140
    v_max3_u32 v12, v12, v141, v142
    v_max3_u32 v12, v12, v143, v143
    v_cmp_eq_u32 vcc, -1, v12
    s_cbranch_vccnz L_retry_28
L_cont_29:
    v_mfma_f32_32x32x16_bf16 a[224:239], a[0:3], v[128:131], 0
    v_and_b32 v14, 31, v1
    v_lshrrev_b32 v15, 5, v1
    v_xor_b32 v15, v15, v14
    v_and_b32 v15, 7, v15
    v_lshlrev_b32 v15, 4, v15
    v_lshl_add_u32 v14, v14, 8, v15
    v_mfma_f32_32x32x16_bf16 a[240:255], a[4:7], v[128:131], 0
    s_lshl_b32 s71, s67, 13
    v_add_u32 v14, s71, v14
    v_xor_b32 v16, 0, v14
    v_xor_b32 v17, 32, v14
    v_xor_b32 v18, 64, v14
    v_xor_b32 v19, 96, v14
    v_lshrrev_b32 v14, 3, v1
    v_mfma_f32_32x32x16_bf16 v[224:239], a[0:3], v[132:135], 0
    v_lshrrev_b32 v15, 3, v9
    v_xor_b32 v15, v15, v14
    v_lshlrev_b32 v15, 4, v15
    v_lshl_add_u32 v15, v14, 8, v15
    s_lshl_b32 s71, s67, 11
    v_add_u32 v20, s71, v15
    v_mfma_f32_32x32x16_bf16 v[240:255], a[4:7], v[132:135], 0
    v_xor_b32 v21, 16, v20
    v_add_u32 v22, 114688, v16
    v_add_u32 v23, 114688, v17
    v_add_u32 v24, 114688, v18
    v_add_u32 v25, 114688, v19
    v_add_u32 v26, 114688, v20
    v_add_u32 v27, 114688, v21
    v_mfma_f32_32x32x16_bf16 a[224:239], a[56:59], v[136:139], a[224:239]
    s_waitcnt vmcnt(19)
    v_max3_u32 v12, v144, v145, v146
    v_max3_u32 v12, v12, v147, v148
    v_max3_u32 v12, v12, v149, v150
    v_max3_u32 v12, v12, v151, v152
    v_max3_u32 v12, v12, v153, v154
    v_max3_u32 v12, v12, v155, v156
    v_mfma_f32_32x32x16_bf16 a[240:255], a[60:63], v[136:139], a[240:255]
    v_max3_u32 v12, v12, v157, v158
    v_max3_u32 v12, v12, v159, v159
    v_cmp_eq_u32 vcc, -1, v12
    v_mfma_f32_32x32x16_bf16 v[224:239], a[56:59], v[140:143], v[224:239]
    v_mfma_f32_32x32x16_bf16 v[240:255], a[60:63], v[140:143], v[240:255]
    s_cbranch_vccnz L_retry_30
L_cont_31:
    v_mfma_f32_32x32x16_bf16 a[224:239], a[112:115], v[144:147], a[224:239]
    s_add_u32 s70, s40, 3072
    buffer_load_dwordx4 v[128:131], v5, s[8:11], s70 offen sc1
    v_mfma_f32_32x32x16_bf16 a[240:255], a[116:119], v[144:147], a[240:255]
    v_mfma_f32_32x32x16_bf16 v[224:239], a[112:115], v[148:151], v[224:239]
    s_add_u32 s70, s44, 3072
    buffer_load_dwordx4 v[132:135], v5, s[8:11], s70 offen sc1
    v_mfma_f32_32x32x16_bf16 v[240:255], a[116:119], v[148:151], v[240:255]
    v_mfma_f32_32x32x16_bf16 a[224:239], a[168:171], v[152:155], a[224:239]
    s_add_u32 s70, s41, 3072
    buffer_load_dwordx4 v[136:139], v5, s[8:11], s70 offen sc1
    s_waitcnt vmcnt(18)
    v_max3_u32 v12, v160, v161, v162
    v_max3_u32 v12, v12, v163, v164
    v_mfma_f32_32x32x16_bf16 a[240:255], a[172:175], v[152:155], a[240:255]
    v_max3_u32 v12, v12, v165, v166
    v_max3_u32 v12, v12, v167, v168
    v_max3_u32 v12, v12, v169, v170
    v_max3_u32 v12, v12, v171, v172
    v_max3_u32 v12, v12, v173, v174
    v_max3_u32 v12, v12, v175, v175
    v_cmp_eq_u32 vcc, -1, v12
    v_mfma_f32_32x32x16_bf16 v[224:239], a[168:171], v[156:159], v[224:239]
    s_add_u32 s70, s45, 3072
    buffer_load_dwordx4 v[140:143], v5, s[8:11], s70 offen sc1
    v_mfma_f32_32x32x16_bf16 v[240:255], a[172:175], v[156:159], v[240:255]
    s_cbranch_vccnz L_retry_32
L_cont_33:
    s_barrier
    buffer_load_dwordx4 v[28:31], v8, s[8:11], s57 offen sc1
    buffer_load_dwordx4 v[32:35], v8, s[8:11], s60 offen sc1
    buffer_load_dwordx4 v[36:39], v9, s[36:39], s77 offen
    v_mfma_f32_32x32x16_bf16 a[224:239], a[8:11], v[160:163], a[224:239]
    s_add_u32 s70, s42, 3072
    buffer_load_dwordx4 v[144:147], v5, s[8:11], s70 offen sc1
    v_mfma_f32_32x32x16_bf16 a[240:255], a[12:15], v[160:163], a[240:255]
    v_mfma_f32_32x32x16_bf16 v[224:239], a[8:11], v[164:167], v[224:239]
    s_add_u32 s70, s46, 3072
    buffer_load_dwordx4 v[148:151], v5, s[8:11], s70 offen sc1
    v_mfma_f32_32x32x16_bf16 v[240:255], a[12:15], v[164:167], v[240:255]
    v_mfma_f32_32x32x16_bf16 a[224:239], a[64:67], v[168:171], a[224:239]
    s_add_u32 s70, s43, 3072
    buffer_load_dwordx4 v[152:155], v5, s[8:11], s70 offen sc1
    s_waitcnt vmcnt(21)
    v_max3_u32 v12, v176, v177, v178
    v_max3_u32 v12, v12, v179, v180
    v_mfma_f32_32x32x16_bf16 a[240:255], a[68:71], v[168:171], a[240:255]
    v_max3_u32 v12, v12, v181, v182
    v_max3_u32 v12, v12, v183, v184
    v_max3_u32 v12, v12, v185, v186
    v_max3_u32 v12, v12, v187, v188
    v_max3_u32 v12, v12, v189, v190
    v_max3_u32 v12, v12, v191, v191
    v_cmp_eq_u32 vcc, -1, v12
    v_mfma_f32_32x32x16_bf16 v[224:239], a[64:67], v[172:175], v[224:239]
    s_add_u32 s70, s47, 3072
    buffer_load_dwordx4 v[156:159], v5, s[8:11], s70 offen sc1
    v_mfma_f32_32x32x16_bf16 v[240:255], a[68:71], v[172:175], v[240:255]
    s_cbranch_vccnz L_retry_34
L_cont_35:
    v_mfma_f32_32x32x16_bf16 a[224:239], a[120:123], v[176:179], a[224:239]
    v_mfma_f32_32x32x16_bf16 a[240:255], a[124:127], v[176:179], a[240:255]
    v_mfma_f32_32x32x16_bf16 v[224:239], a[120:123], v[180:183], v[224:239]
    v_mfma_f32_32x32x16_bf16 v[240:255], a[124:127], v[180:183], v[240:255]
    v_mfma_f32_32x32x16_bf16 a[224:239], a[176:179], v[184:187], a[224:239]
    s_add_u32 s70, s40, 4096
    buffer_load_dwordx4 v[160:163], v5, s[8:11], s70 offen sc1
    s_waitcnt vmcnt(18)
    v_max3_u32 v12, v192, v193, v194
    v_max3_u32 v12, v12, v195, v196
    v_mfma_f32_32x32x16_bf16 a[240:255], a[180:183], v[184:187], a[240:255]
    v_max3_u32 v12, v12, v197, v198
    v_max3_u32 v12, v12, v199, v200
    v_max3_u32 v12, v12, v201, v202
    v_max3_u32 v12, v12, v203, v204
    v_max3_u32 v12, v12, v205, v206
    v_max3_u32 v12, v12, v207, v207
    v_cmp_eq_u32 vcc, -1, v12
    v_mfma_f32_32x32x16_bf16 v[224:239], a[176:179], v[188:191], v[224:239]
    s_add_u32 s70, s41, 4096
    buffer_load_dwordx4 v[164:167], v5, s[8:11], s70 offen sc1
    v_mfma_f32_32x32x16_bf16 v[240:255], a[180:183], v[188:191], v[240:255]
    s_cbranch_vccnz L_retry_36
L_cont_37:
    v_mfma_f32_32x32x16_bf16 a[224:239], a[16:19], v[192:195], a[224:239]
    s_add_u32 s70, s42, 4096
    buffer_load_dwordx4 v[168:171], v5, s[8:11], s70 offen sc1
    v_mfma_f32_32x32x16_bf16 a[240:255], a[20:23], v[192:195], a[240:255]
    v_mfma_f32_32x32x16_bf16 v[224:239], a[16:19], v[196:199], v[224:239]
    s_add_u32 s70, s43, 4096
    buffer_load_dwordx4 v[172:175], v5, s[8:11], s70 offen sc1
    v_mfma_f32_32x32x16_bf16 v[240:255], a[20:23], v[196:199], v[240:255]
    v_mfma_f32_32x32x16_bf16 a[224:239], a[72:75], v[200:203], a[224:239]
    s_add_u32 s70, s40, 5120
    buffer_load_dwordx4 v[176:179], v5, s[8:11], s70 offen sc1
    s_waitcnt vmcnt(17)
    v_max3_u32 v12, v208, v209, v210
    v_max3_u32 v12, v12, v211, v212
    v_mfma_f32_32x32x16_bf16 a[240:255], a[76:79], v[200:203], a[240:255]
    v_max3_u32 v12, v12, v213, v214
    v_max3_u32 v12, v12, v215, v216
    v_max3_u32 v12, v12, v217, v218
    v_max3_u32 v12, v12, v219, v220
    v_max3_u32 v12, v12, v221, v222
    v_max3_u32 v12, v12, v223, v223
    v_cmp_eq_u32 vcc, -1, v12
    v_mfma_f32_32x32x16_bf16 v[224:239], a[72:75], v[204:207], v[224:239]
    s_add_u32 s70, s41, 5120
    buffer_load_dwordx4 v[180:183], v5, s[8:11], s70 offen sc1
    v_mfma_f32_32x32x16_bf16 v[240:255], a[76:79], v[204:207], v[240:255]
    s_cbranch_vccnz L_retry_38
L_cont_39:
    v_mfma_f32_32x32x16_bf16 a[224:239], a[128:131], v[208:211], a[224:239]
    s_add_u32 s70, s42, 5120
    buffer_load_dwordx4 v[184:187], v5, s[8:11], s70 offen sc1
    v_mfma_f32_32x32x16_bf16 a[240:255], a[132:135], v[208:211], a[240:255]
    v_mfma_f32_32x32x16_bf16 v[224:239], a[128:131], v[212:215], v[224:239]
    s_add_u32 s70, s43, 5120
    buffer_load_dwordx4 v[188:191], v5, s[8:11], s70 offen sc1
    v_mfma_f32_32x32x16_bf16 v[240:255], a[132:135], v[212:215], v[240:255]
    v_mfma_f32_32x32x16_bf16 a[224:239], a[184:187], v[216:219], a[224:239]
    s_add_u32 s70, s40, 6144
    buffer_load_dwordx4 v[192:195], v5, s[8:11], s70 offen sc1
    s_waitcnt vmcnt(16)
    v_max3_u32 v12, v128, v129, v130
    v_max3_u32 v12, v12, v131, v132
    v_mfma_f32_32x32x16_bf16 a[240:255], a[188:191], v[216:219], a[240:255]
    v_max3_u32 v12, v12, v133, v134
    v_max3_u32 v12, v12, v135, v136
    v_max3_u32 v12, v12, v137, v138
    v_max3_u32 v12, v12, v139, v140
    v_max3_u32 v12, v12, v141, v142
    v_max3_u32 v12, v12, v143, v143
    v_cmp_eq_u32 vcc, -1, v12
    v_mfma_f32_32x32x16_bf16 v[224:239], a[184:187], v[220:223], v[224:239]
    s_add_u32 s70, s41, 6144
    buffer_load_dwordx4 v[196:199], v5, s[8:11], s70 offen sc1
    v_mfma_f32_32x32x16_bf16 v[240:255], a[188:191], v[220:223], v[240:255]
    s_cbranch_vccnz L_retry_40
L_cont_41:
    v_mfma_f32_32x32x16_bf16 a[224:239], a[24:27], v[128:131], a[224:239]
    s_add_u32 s70, s42, 6144
    buffer_load_dwordx4 v[200:203], v5, s[8:11], s70 offen sc1
    v_mfma_f32_32x32x16_bf16 a[240:255], a[28:31], v[128:131], a[240:255]
    v_mfma_f32_32x32x16_bf16 v[224:239], a[24:27], v[132:135], v[224:239]
    s_add_u32 s70, s43, 6144
    buffer_load_dwordx4 v[204:207], v5, s[8:11], s70 offen sc1
    v_mfma_f32_32x32x16_bf16 v[240:255], a[28:31], v[132:135], v[240:255]
    v_mfma_f32_32x32x16_bf16 a[224:239], a[80:83], v[136:139], a[224:239]
    s_add_u32 s70, s44, 4096
    buffer_load_dwordx4 v[208:211], v5, s[8:11], s70 offen sc1
    s_waitcnt vmcnt(13)
    v_max3_u32 v12, v144, v145, v146
    v_max3_u32 v12, v12, v147, v148
    v_mfma_f32_32x32x16_bf16 a[240:255], a[84:87], v[136:139], a[240:255]
    v_max3_u32 v12, v12, v149, v150
    v_max3_u32 v12, v12, v151, v152
    v_max3_u32 v12, v12, v153, v154
    v_max3_u32 v12, v12, v155, v156
    v_max3_u32 v12, v12, v157, v158
    v_max3_u32 v12, v12, v159, v159
    v_cmp_eq_u32 vcc, -1, v12
    v_mfma_f32_32x32x16_bf16 v[224:239], a[80:83], v[140:143], v[224:239]
    s_add_u32 s70, s45, 4096
    buffer_load_dwordx4 v[212:215], v5, s[8:11], s70 offen sc1
    v_mfma_f32_32x32x16_bf16 v[240:255], a[84:87], v[140:143], v[240:255]
    s_cbranch_vccnz L_retry_42
L_cont_43:
    v_mfma_f32_32x32x16_bf16 a[224:239], a[136:139], v[144:147], a[224:239]
    s_add_u32 s70, s46, 4096
    buffer_load_dwordx4 v[216:219], v5, s[8:11], s70 offen sc1
    v_mfma_f32_32x32x16_bf16 a[240:255], a[140:143], v[144:147], a[240:255]
    v_mfma_f32_32x32x16_bf16 v[224:239], a[136:139], v[148:151], v[224:239]
    s_add_u32 s70, s47, 4096
    buffer_load_dwordx4 v[220:223], v5, s[8:11], s70 offen sc1
    v_mfma_f32_32x32x16_bf16 v[240:255], a[140:143], v[148:151], v[240:255]
    v_mfma_f32_32x32x16_bf16 a[224:239], a[192:195], v[152:155], a[224:239]
    s_add_u32 s70, s44, 5120
    buffer_load_dwordx4 v[128:131], v5, s[8:11], s70 offen sc1
    s_waitcnt vmcnt(13)
    v_max3_u32 v12, v160, v161, v162
    v_max3_u32 v12, v12, v163, v164
    v_mfma_f32_32x32x16_bf16 a[240:255], a[196:199], v[152:155], a[240:255]
    v_max3_u32 v12, v12, v165, v166
    v_max3_u32 v12, v12, v167, v168
    v_max3_u32 v12, v12, v169, v170
    v_max3_u32 v12, v12, v171, v172
    v_max3_u32 v12, v12, v173, v174
    v_max3_u32 v12, v12, v175, v175
    v_cmp_eq_u32 vcc, -1, v12
    v_mfma_f32_32x32x16_bf16 v[224:239], a[192:195], v[156:159], v[224:239]
    s_add_u32 s70, s45, 5120
    buffer_load_dwordx4 v[132:135], v5, s[8:11], s70 offen sc1
    v_mfma_f32_32x32x16_bf16 v[240:255], a[196:199], v[156:159], v[240:255]
    s_cbranch_vccnz L_retry_44
L_cont_45:
    v_mfma_f32_32x32x16_bf16 a[224:239], a[32:35], v[160:163], a[224:239]
    s_add_u32 s70, s46, 5120
    buffer_load_dwordx4 v[136:139], v5, s[8:11], s70 offen sc1
    v_mfma_f32_32x32x16_bf16 a[240:255], a[36:39], v[160:163], a[240:255]
    v_mfma_f32_32x32x16_bf16 a[224:239], a[88:91], v[164:167], a[224:239]
    s_add_u32 s70, s47, 5120
    buffer_load_dwordx4 v[140:143], v5, s[8:11], s70 offen sc1
    v_lshlrev_b32 v48, 16, v36
    v_and_b32 v49, s78, v36
    v_mfma_f32_32x32x16_bf16 a[240:255], a[92:95], v[164:167], a[240:255]
    v_lshlrev_b32 v50, 16, v37
    v_and_b32 v51, s78, v37
    v_lshlrev_b32 v52, 16, v38
    v_and_b32 v53, s78, v38
    v_lshlrev_b32 v54, 16, v39
    v_and_b32 v55, s78, v39
    v_lshlrev_b32 v40, 16, v28
    v_mfma_f32_32x32x16_bf16 a[224:239], a[144:147], v[168:171], a[224:239]
    s_add_u32 s70, s44, 6144
    buffer_load_dwordx4 v[144:147], v5, s[8:11], s70 offen sc1
    s_waitcnt vmcnt(13)
    v_max3_u32 v12, v176, v177, v178
    v_max3_u32 v12, v12, v179, v180
    v_mfma_f32_32x32x16_bf16 a[240:255], a[148:151], v[168:171], a[240:255]
    v_max3_u32 v12, v12, v181, v182
    v_max3_u32 v12, v12, v183, v184
    v_max3_u32 v12, v12, v185, v186
    v_max3_u32 v12, v12, v187, v188
    v_max3_u32 v12, v12, v189, v190
    v_max3_u32 v12, v12, v191, v191
    v_cmp_eq_u32 vcc, -1, v12
    v_mfma_f32_32x32x16_bf16 a[224:239], a[200:203], v[172:175], a[224:239]
    s_add_u32 s70, s45, 6144
    buffer_load_dwordx4 v[148:151], v5, s[8:11], s70 offen sc1
    v_and_b32 v41, s78, v28
    v_lshlrev_b32 v42, 16, v29
    v_mfma_f32_32x32x16_bf16 a[240:255], a[204:207], v[172:175], a[240:255]
    v_and_b32 v43, s78, v29
    v_lshlrev_b32 v44, 16, v30
    v_and_b32 v45, s78, v30
    v_lshlrev_b32 v46, 16, v31
    v_and_b32 v47, s78, v31
    v_add_f32 v40, v40, v48
    v_add_f32 v41, v41, v49
    s_cbranch_vccnz L_retry_46
L_cont_47:
    v_mfma_f32_32x32x16_bf16 a[224:239], a[40:43], v[176:179], a[224:239]
    s_add_u32 s70, s46, 6144
    buffer_load_dwordx4 v[152:155], v5, s[8:11], s70 offen sc1
    v_add_f32 v42, v42, v50
    v_add_f32 v43, v43, v51
    v_mfma_f32_32x32x16_bf16 a[240:255], a[44:47], v[176:179], a[240:255]
    v_add_f32 v44, v44, v52
    v_add_f32 v45, v45, v53
    v_add_f32 v46, v46, v54
    v_add_f32 v47, v47, v55
    v_mfma_f32_32x32x16_bf16 a[224:239], a[96:99], v[180:183], a[224:239]
    s_add_u32 s70, s47, 6144
    buffer_load_dwordx4 v[156:159], v5, s[8:11], s70 offen sc1
    v_mfma_f32_32x32x16_bf16 a[240:255], a[100:103], v[180:183], a[240:255]
    v_mfma_f32_32x32x16_bf16 a[224:239], a[152:155], v[184:187], a[224:239]
    s_waitcnt vmcnt(12)
    v_max3_u32 v12, v192, v193, v194
    v_max3_u32 v12, v12, v195, v196
    v_max3_u32 v12, v12, v197, v198
    v_max3_u32 v12, v12, v199, v200
    v_max3_u32 v12, v12, v201, v202
    v_max3_u32 v12, v12, v203, v204
    v_mfma_f32_32x32x16_bf16 a[240:255], a[156:159], v[184:187], a[240:255]
    v_max3_u32 v12, v12, v205, v206
    v_max3_u32 v12, v12, v207, v207
    v_cmp_eq_u32 vcc, -1, v12
    v_mfma_f32_32x32x16_bf16 a[224:239], a[208:211], v[188:191], a[224:239]
    v_mfma_f32_32x32x16_bf16 a[240:255], a[212:215], v[188:191], a[240:255]
    s_cbranch_vccnz L_retry_48
L_cont_49:
    v_mfma_f32_32x32x16_bf16 a[224:239], a[48:51], v[192:195], a[224:239]
    v_mfma_f32_32x32x16_bf16 a[240:255], a[52:55], v[192:195], a[240:255]
    v_mfma_f32_32x32x16_bf16 a[224:239], a[104:107], v[196:199], a[224:239]
    v_mfma_f32_32x32x16_bf16 a[240:255], a[108:111], v[196:199], a[240:255]
    v_mfma_f32_32x32x16_bf16 a[224:239], a[160:163], v[200:203], a[224:239]
    s_waitcnt vmcnt(8)
    v_max3_u32 v12, v208, v209, v210
    v_max3_u32 v12, v12, v211, v212
    v_max3_u32 v12, v12, v213, v214
    v_max3_u32 v12, v12, v215, v216
    v_max3_u32 v12, v12, v217, v218
    v_max3_u32 v12, v12, v219, v220
    v_mfma_f32_32x32x16_bf16 a[240:255], a[164:167], v[200:203], a[240:255]
    v_max3_u32 v12, v12, v221, v222
    v_max3_u32 v12, v12, v223, v223
    v_cmp_eq_u32 vcc, -1, v12
    v_mfma_f32_32x32x16_bf16 a[224:239], a[216:219], v[204:207], a[224:239]
    v_mfma_f32_32x32x16_bf16 a[240:255], a[220:223], v[204:207], a[240:255]
    s_cbranch_vccnz L_retry_50
L_cont_51:
    v_mfma_f32_32x32x16_bf16 v[224:239], a[32:35], v[208:211], v[224:239]
    v_mfma_f32_32x32x16_bf16 v[240:255], a[36:39], v[208:211], v[240:255]
    v_mfma_f32_32x32x16_bf16 v[224:239], a[88:91], v[212:215], v[224:239]
    v_mfma_f32_32x32x16_bf16 v[240:255], a[92:95], v[212:215], v[240:255]
    v_mfma_f32_32x32x16_bf16 v[224:239], a[144:147], v[216:219], v[224:239]
    s_waitcnt vmcnt(4)
    v_max3_u32 v12, v128, v129, v130
    v_max3_u32 v12, v12, v131, v132
    v_max3_u32 v12, v12, v133, v134
    v_max3_u32 v12, v12, v135, v136
    v_max3_u32 v12, v12, v137, v138
    v_max3_u32 v12, v12, v139, v140
    v_mfma_f32_32x32x16_bf16 v[240:255], a[148:151], v[216:219], v[240:255]
    v_max3_u32 v12, v12, v141, v142
    v_max3_u32 v12, v12, v143, v143
    v_cmp_eq_u32 vcc, -1, v12
    ds_write_b128 v22, a[224:227] offset:0
    ds_write_b128 v23, a[228:231] offset:0
    ds_write_b128 v24, a[232:235] offset:0
    ds_write_b128 v25, a[236:239] offset:0
    v_mfma_f32_32x32x16_bf16 v[224:239], a[200:203], v[220:223], v[224:239]
    ds_write_b128 v22, a[240:243] offset:128
    ds_write_b128 v23, a[244:247] offset:128
    ds_write_b128 v24, a[248:251] offset:128
    ds_write_b128 v25, a[252:255] offset:128
    s_waitcnt lgkmcnt(0)
    s_barrier
    ds_read_b128 v[64:67], v26 offset:0
    v_mfma_f32_32x32x16_bf16 v[240:255], a[204:207], v[220:223], v[240:255]
    ds_read_b128 v[68:71], v27 offset:0
    ds_read_b128 v[72:75], v26 offset:8192
    ds_read_b128 v[76:79], v27 offset:8192
    ds_read_b128 v[80:83], v26 offset:16384
    ds_read_b128 v[84:87], v27 offset:16384
    ds_read_b128 v[88:91], v26 offset:24576
    ds_read_b128 v[92:95], v27 offset:24576
    s_cbranch_vccnz L_retry_52
L_cont_53:
    v_mfma_f32_32x32x16_bf16 v[224:239], a[40:43], v[128:131], v[224:239]
    s_waitcnt lgkmcnt(6)
    v_add_f32 v40, v40, v64
    v_add_f32 v41, v41, v65
    v_add_f32 v42, v42, v66
    v_add_f32 v43, v43, v67
    v_add_f32 v44, v44, v68
    v_add_f32 v45, v45, v69
    v_mfma_f32_32x32x16_bf16 v[240:255], a[44:47], v[128:131], v[240:255]
    v_add_f32 v46, v46, v70
    v_add_f32 v47, v47, v71
    s_waitcnt lgkmcnt(4)
    v_add_f32 v40, v40, v72
    v_add_f32 v41, v41, v73
    v_add_f32 v42, v42, v74
    v_add_f32 v43, v43, v75
    v_add_f32 v44, v44, v76
    v_mfma_f32_32x32x16_bf16 v[224:239], a[96:99], v[132:135], v[224:239]
    v_add_f32 v45, v45, v77
    v_add_f32 v46, v46, v78
    v_add_f32 v47, v47, v79
    s_waitcnt lgkmcnt(2)
    v_add_f32 v40, v40, v80
    v_add_f32 v41, v41, v81
    v_add_f32 v42, v42, v82
    v_mfma_f32_32x32x16_bf16 v[240:255], a[100:103], v[132:135], v[240:255]
    v_add_f32 v43, v43, v83
    v_add_f32 v44, v44, v84
    v_add_f32 v45, v45, v85
    v_add_f32 v46, v46, v86
    v_add_f32 v47, v47, v87
    s_waitcnt lgkmcnt(0)
    v_add_f32 v40, v40, v88
    v_add_f32 v41, v41, v89
    v_mfma_f32_32x32x16_bf16 v[224:239], a[152:155], v[136:139], v[224:239]
    s_waitcnt vmcnt(0)
    v_max3_u32 v12, v144, v145, v146
    v_max3_u32 v12, v12, v147, v148
    v_max3_u32 v12, v12, v149, v150
    v_max3_u32 v12, v12, v151, v152
    v_max3_u32 v12, v12, v153, v154
    v_max3_u32 v12, v12, v155, v156
    v_mfma_f32_32x32x16_bf16 v[240:255], a[156:159], v[136:139], v[240:255]
    v_max3_u32 v12, v12, v157, v158
    v_max3_u32 v12, v12, v159, v159
    v_cmp_eq_u32 vcc, -1, v12
    v_add_f32 v42, v42, v90
    v_add_f32 v43, v43, v91
    v_add_f32 v44, v44, v92
    v_add_f32 v45, v45, v93
    v_mfma_f32_32x32x16_bf16 v[224:239], a[208:211], v[140:143], v[224:239]
    v_add_f32 v46, v46, v94
    v_add_f32 v47, v47, v95
    v_cvt_pk_bf16_f32 v56, v40, v41
    v_cvt_pk_bf16_f32 v57, v42, v43
    v_cvt_pk_bf16_f32 v58, v44, v45
    v_cvt_pk_bf16_f32 v59, v46, v47
    v_mfma_f32_32x32x16_bf16 v[240:255], a[212:215], v[140:143], v[240:255]
    buffer_store_dwordx4 v[56:59], v8, s[20:23], s55 offen sc1
    v_lshlrev_b32 v40, 16, v32
    v_and_b32 v41, s78, v32
    v_lshlrev_b32 v42, 16, v33
    v_and_b32 v43, s78, v33
    v_lshlrev_b32 v44, 16, v34
    v_and_b32 v45, s78, v34
    s_cbranch_vccnz L_retry_54
L_cont_55:
    v_mfma_f32_32x32x16_bf16 v[224:239], a[48:51], v[144:147], v[224:239]
    v_lshlrev_b32 v46, 16, v35
    v_and_b32 v47, s78, v35
    v_add_f32 v40, v40, v48
    v_add_f32 v41, v41, v49
    v_add_f32 v42, v42, v50
    v_add_f32 v43, v43, v51
    v_mfma_f32_32x32x16_bf16 v[240:255], a[52:55], v[144:147], v[240:255]
    v_add_f32 v44, v44, v52
    v_add_f32 v45, v45, v53
    v_add_f32 v46, v46, v54
    v_add_f32 v47, v47, v55
    v_mfma_f32_32x32x16_bf16 v[224:239], a[104:107], v[148:151], v[224:239]
    v_mfma_f32_32x32x16_bf16 v[240:255], a[108:111], v[148:151], v[240:255]
    v_mfma_f32_32x32x16_bf16 v[224:239], a[160:163], v[152:155], v[224:239]
    v_mfma_f32_32x32x16_bf16 v[240:255], a[164:167], v[152:155], v[240:255]
    v_mfma_f32_32x32x16_bf16 v[224:239], a[216:219], v[156:159], v[224:239]
    v_mfma_f32_32x32x16_bf16 v[240:255], a[220:223], v[156:159], v[240:255]
    s_nop 7
    s_nop 2
    ds_write_b128 v16, v[224:227] offset:0
    ds_write_b128 v17, v[228:231] offset:0
    ds_write_b128 v18, v[232:235] offset:0
    ds_write_b128 v19, v[236:239] offset:0
    ds_write_b128 v16, v[240:243] offset:128
    ds_write_b128 v17, v[244:247] offset:128
    ds_write_b128 v18, v[248:251] offset:128
    ds_write_b128 v19, v[252:255] offset:128
    s_waitcnt lgkmcnt(0)
    s_barrier
    ds_read_b128 v[128:131], v20 offset:0
    ds_read_b128 v[132:135], v21 offset:0
    ds_read_b128 v[136:139], v20 offset:8192
    ds_read_b128 v[140:143], v21 offset:8192
    ds_read_b128 v[144:147], v20 offset:16384
    ds_read_b128 v[148:151], v21 offset:16384
    ds_read_b128 v[152:155], v20 offset:24576
    ds_read_b128 v[156:159], v21 offset:24576
    s_waitcnt lgkmcnt(6)
    v_pk_add_f32 v[40:41], v[40:41], v[128:129]
    v_pk_add_f32 v[42:43], v[42:43], v[130:131]
    v_pk_add_f32 v[44:45], v[44:45], v[132:133]
    v_pk_add_f32 v[46:47], v[46:47], v[134:135]
    s_waitcnt lgkmcnt(4)
    v_pk_add_f32 v[40:41], v[40:41], v[136:137]
    v_pk_add_f32 v[42:43], v[42:43], v[138:139]
    v_pk_add_f32 v[44:45], v[44:45], v[140:141]
    v_pk_add_f32 v[46:47], v[46:47], v[142:143]
    s_waitcnt lgkmcnt(2)
    v_pk_add_f32 v[40:41], v[40:41], v[144:145]
    v_pk_add_f32 v[42:43], v[42:43], v[146:147]
    v_pk_add_f32 v[44:45], v[44:45], v[148:149]
    v_pk_add_f32 v[46:47], v[46:47], v[150:151]
    s_waitcnt lgkmcnt(0)
    v_pk_add_f32 v[40:41], v[40:41], v[152:153]
    v_pk_add_f32 v[42:43], v[42:43], v[154:155]
    v_pk_add_f32 v[44:45], v[44:45], v[156:157]
    v_pk_add_f32 v[46:47], v[46:47], v[158:159]
    v_cvt_pk_bf16_f32 v60, v40, v41
    v_cvt_pk_bf16_f32 v61, v42, v43
    v_cvt_pk_bf16_f32 v62, v44, v45
    v_cvt_pk_bf16_f32 v63, v46, v47
    buffer_store_dwordx4 v[60:63], v8, s[20:23], s56 offen sc1
L_end:
    s_endpgm
L_retry_1:
    s_nop 7
    s_nop 7
    s_sub_u32 s69, s69, 1
    s_cbranch_scc1 L_retry_1_to
    buffer_load_dword v212, v213, s[8:11], s54 offen sc1
    s_waitcnt vmcnt(0)
    v_cmp_ne_u32 vcc, s68, v212
    s_cbranch_vccnz L_retry_1
    s_nop 7
    s_branch L_cont_2
L_retry_1_to:
    s_mov_b32 s69, 0
    s_nop 7
    s_branch L_cont_2
L_retry_3:
    s_nop 7
    s_nop 7
    s_sub_u32 s69, s69, 1
    s_cbranch_scc1 L_retry_3_to
    buffer_load_dwordx4 v[192:195], v4, s[8:11], s70 offen sc1
    buffer_load_dwordx4 v[196:199], v4, s[8:11], s71 offen sc1
    s_waitcnt vmcnt(0)
    v_max3_u32 v12, v192, v193, v194
    v_max3_u32 v12, v12, v195, v196
    v_max3_u32 v12, v12, v197, v198
    v_max3_u32 v12, v12, v199, v199
    v_cmp_eq_u32 vcc, -1, v12
    s_cbranch_vccnz L_retry_3
    s_nop 7
    s_branch L_cont_4
L_retry_3_to:
    s_mov_b32 s69, 0
    s_nop 7
    s_branch L_cont_4
L_retry_5:
    s_nop 7
    s_nop 7
    s_sub_u32 s69, s69, 1
    s_cbranch_scc1 L_retry_5_to
    buffer_load_dwordx4 v[240:243], v14, s[8:11], s56 offen offset:0 sc1
    buffer_load_dwordx4 v[244:247], v14, s[8:11], s56 offen offset:2048 sc1
    buffer_load_dwordx4 v[248:251], v14, s[8:11], s55 offen offset:0 sc1
    buffer_load_dwordx4 v[252:255], v14, s[8:11], s55 offen offset:2048 sc1
    s_waitcnt vmcnt(0)
    v_cmp_ne_u64 vcc, s[46:47], v[242:243]
    v_cmp_ne_u64 s[40:41], s[46:47], v[246:247]
    v_cmp_ne_u64 s[42:43], s[46:47], v[250:251]
    v_cmp_ne_u64 s[44:45], s[46:47], v[254:255]
    s_or_b64 vcc, vcc, s[40:41]
    s_or_b64 vcc, vcc, s[42:43]
    s_or_b64 vcc, vcc, s[44:45]
    s_cbranch_vccnz L_retry_5
    s_nop 7
    s_branch L_cont_6
L_retry_5_to:
    s_mov_b32 s69, 0
    s_nop 7
    s_branch L_cont_6
L_retry_8:
    s_nop 7
    s_nop 7
    s_sub_u32 s69, s69, 1
    s_cbranch_scc1 L_retry_8_to
    buffer_load_dword v144, v145, s[8:11], s72 offen sc1
    s_waitcnt vmcnt(0)
    v_cmp_ne_u32 vcc, s68, v144
    s_cbranch_vccnz L_retry_8
    s_nop 7
    s_branch L_cont_9
L_retry_8_to:
    s_mov_b32 s69, 0
    s_nop 7
    s_branch L_cont_9
L_retry_10:
    s_nop 7
    s_nop 7
    s_sub_u32 s69, s69, 1
    s_cbranch_scc1 L_retry_10_to
    buffer_load_dwordx4 v[104:107], v4, s[8:11], s70 offen sc1
    buffer_load_dwordx4 v[108:111], v4, s[8:11], s71 offen sc1
    s_waitcnt vmcnt(0)
    v_max3_u32 v12, v104, v105, v106
    v_max3_u32 v12, v12, v107, v108
    v_max3_u32 v12, v12, v109, v110
    v_max3_u32 v12, v12, v111, v111
    v_cmp_eq_u32 vcc, -1, v12
    s_cbranch_vccnz L_retry_10
    s_nop 7
    s_branch L_cont_11
L_retry_10_to:
    s_mov_b32 s69, 0
    s_nop 7
    s_branch L_cont_11
L_retry_12:
    s_nop 7
    s_nop 7
    s_sub_u32 s69, s69, 1
    s_cbranch_scc1 L_retry_12_to
    buffer_load_dwordx4 v[128:131], v5, s[8:11], s40 offen offset:0 sc1
    buffer_load_dwordx4 v[132:135], v5, s[8:11], s40 offen offset:1024 sc1
    buffer_load_dwordx4 v[136:139], v5, s[8:11], s40 offen offset:2048 sc1
    buffer_load_dwordx4 v[140:143], v5, s[8:11], s40 offen offset:3072 sc1
    s_waitcnt vmcnt(0)
    v_max3_u32 v40, v128, v129, v130
    v_max3_u32 v40, v40, v131, v132
    v_max3_u32 v40, v40, v133, v134
    v_max3_u32 v40, v40, v135, v136
    v_max3_u32 v40, v40, v137, v138
    v_max3_u32 v40, v40, v139, v140
    v_max3_u32 v40, v40, v141, v142
    v_max3_u32 v40, v40, v143, v143
    v_cmp_eq_u32 vcc, -1, v40
    s_cbranch_vccnz L_retry_12
    s_nop 7
    s_branch L_cont_13
L_retry_12_to:
    s_mov_b32 s69, 0
    s_nop 7
    s_branch L_cont_13
L_retry_14:
    s_nop 7
    s_nop 7
    s_sub_u32 s69, s69, 1
    s_cbranch_scc1 L_retry_14_to
    buffer_load_dwordx4 v[144:147], v5, s[8:11], s41 offen offset:0 sc1
    buffer_load_dwordx4 v[148:151], v5, s[8:11], s41 offen offset:1024 sc1
    buffer_load_dwordx4 v[152:155], v5, s[8:11], s41 offen offset:2048 sc1
    buffer_load_dwordx4 v[156:159], v5, s[8:11], s41 offen offset:3072 sc1
    s_waitcnt vmcnt(0)
    v_max3_u32 v40, v144, v145, v146
    v_max3_u32 v40, v40, v147, v148
    v_max3_u32 v40, v40, v149, v150
    v_max3_u32 v40, v40, v151, v152
    v_max3_u32 v40, v40, v153, v154
    v_max3_u32 v40, v40, v155, v156
    v_max3_u32 v40, v40, v157, v158
    v_max3_u32 v40, v40, v159, v159
    v_cmp_eq_u32 vcc, -1, v40
    s_cbranch_vccnz L_retry_14
    s_nop 7
    s_branch L_cont_15
L_retry_14_to:
    s_mov_b32 s69, 0
    s_nop 7
    s_branch L_cont_15
L_retry_16:
    s_nop 7
    s_nop 7
    s_sub_u32 s69, s69, 1
    s_cbranch_scc1 L_retry_16_to
    buffer_load_dwordx4 v[160:163], v5, s[8:11], s42 offen offset:0 sc1
    buffer_load_dwordx4 v[164:167], v5, s[8:11], s42 offen offset:1024 sc1
    buffer_load_dwordx4 v[168:171], v5, s[8:11], s42 offen offset:2048 sc1
    buffer_load_dwordx4 v[172:175], v5, s[8:11], s42 offen offset:3072 sc1
    s_waitcnt vmcnt(0)
    v_max3_u32 v40, v160, v161, v162
    v_max3_u32 v40, v40, v163, v164
    v_max3_u32 v40, v40, v165, v166
    v_max3_u32 v40, v40, v167, v168
    v_max3_u32 v40, v40, v169, v170
    v_max3_u32 v40, v40, v171, v172
    v_max3_u32 v40, v40, v173, v174
    v_max3_u32 v40, v40, v175, v175
    v_cmp_eq_u32 vcc, -1, v40
    s_cbranch_vccnz L_retry_16
    s_nop 7
    s_branch L_cont_17
L_retry_16_to:
    s_mov_b32 s69, 0
    s_nop 7
    s_branch L_cont_17
L_retry_18:
    s_nop 7
    s_nop 7
    s_sub_u32 s69, s69, 1
    s_cbranch_scc1 L_retry_18_to
    buffer_load_dwordx4 v[176:179], v5, s[8:11], s43 offen offset:0 sc1
    buffer_load_dwordx4 v[180:183], v5, s[8:11], s43 offen offset:1024 sc1
    buffer_load_dwordx4 v[184:187], v5, s[8:11], s43 offen offset:2048 sc1
    buffer_load_dwordx4 v[188:191], v5, s[8:11], s43 offen offset:3072 sc1
    s_waitcnt vmcnt(0)
    v_max3_u32 v40, v176, v177, v178
    v_max3_u32 v40, v40, v179, v180
    v_max3_u32 v40, v40, v181, v182
    v_max3_u32 v40, v40, v183, v184
    v_max3_u32 v40, v40, v185, v186
    v_max3_u32 v40, v40, v187, v188
    v_max3_u32 v40, v40, v189, v190
    v_max3_u32 v40, v40, v191, v191
    v_cmp_eq_u32 vcc, -1, v40
    s_cbranch_vccnz L_retry_18
    s_nop 7
    s_branch L_cont_19
L_retry_18_to:
    s_mov_b32 s69, 0
    s_nop 7
    s_branch L_cont_19
L_retry_20:
    s_nop 7
    s_nop 7
    s_sub_u32 s69, s69, 1
    s_cbranch_scc1 L_retry_20_to
    buffer_load_dwordx4 v[192:195], v5, s[8:11], s44 offen offset:0 sc1
    buffer_load_dwordx4 v[196:199], v5, s[8:11], s44 offen offset:1024 sc1
    buffer_load_dwordx4 v[200:203], v5, s[8:11], s44 offen offset:2048 sc1
    buffer_load_dwordx4 v[204:207], v5, s[8:11], s44 offen offset:3072 sc1
    s_waitcnt vmcnt(0)
    v_max3_u32 v40, v192, v193, v194
    v_max3_u32 v40, v40, v195, v196
    v_max3_u32 v40, v40, v197, v198
    v_max3_u32 v40, v40, v199, v200
    v_max3_u32 v40, v40, v201, v202
    v_max3_u32 v40, v40, v203, v204
    v_max3_u32 v40, v40, v205, v206
    v_max3_u32 v40, v40, v207, v207
    v_cmp_eq_u32 vcc, -1, v40
    s_cbranch_vccnz L_retry_20
    s_nop 7
    s_branch L_cont_21
L_retry_20_to:
    s_mov_b32 s69, 0
    s_nop 7
    s_branch L_cont_21
L_retry_22:
    s_nop 7
    s_nop 7
    s_sub_u32 s69, s69, 1
    s_cbranch_scc1 L_retry_22_to
    buffer_load_dwordx4 v[208:211], v5, s[8:11], s45 offen offset:0 sc1
    buffer_load_dwordx4 v[212:215], v5, s[8:11], s45 offen offset:1024 sc1
    buffer_load_dwordx4 v[216:219], v5, s[8:11], s45 offen offset:2048 sc1
    buffer_load_dwordx4 v[220:223], v5, s[8:11], s45 offen offset:3072 sc1
    s_waitcnt vmcnt(0)
    v_max3_u32 v40, v208, v209, v210
    v_max3_u32 v40, v40, v211, v212
    v_max3_u32 v40, v40, v213, v214
    v_max3_u32 v40, v40, v215, v216
    v_max3_u32 v40, v40, v217, v218
    v_max3_u32 v40, v40, v219, v220
    v_max3_u32 v40, v40, v221, v222
    v_max3_u32 v40, v40, v223, v223
    v_cmp_eq_u32 vcc, -1, v40
    s_cbranch_vccnz L_retry_22
    s_nop 7
    s_branch L_cont_23
L_retry_22_to:
    s_mov_b32 s69, 0
    s_nop 7
    s_branch L_cont_23
L_retry_24:
    s_nop 7
    s_nop 7
    s_sub_u32 s69, s69, 1
    s_cbranch_scc1 L_retry_24_to
    buffer_load_dwordx4 v[224:227], v5, s[8:11], s46 offen offset:0 sc1
    buffer_load_dwordx4 v[228:231], v5, s[8:11], s46 offen offset:1024 sc1
    buffer_load_dwordx4 v[232:235], v5, s[8:11], s46 offen offset:2048 sc1
    buffer_load_dwordx4 v[236:239], v5, s[8:11], s46 offen offset:3072 sc1
    s_waitcnt vmcnt(0)
    v_max3_u32 v40, v224, v225, v226
    v_max3_u32 v40, v40, v227, v228
    v_max3_u32 v40, v40, v229, v230
    v_max3_u32 v40, v40, v231, v232
    v_max3_u32 v40, v40, v233, v234
    v_max3_u32 v40, v40, v235, v236
    v_max3_u32 v40, v40, v237, v238
    v_max3_u32 v40, v40, v239, v239
    v_cmp_eq_u32 vcc, -1, v40
    s_cbranch_vccnz L_retry_24
    s_nop 7
    s_branch L_cont_25
L_retry_24_to:
    s_mov_b32 s69, 0
    s_nop 7
    s_branch L_cont_25
L_retry_26:
    s_nop 7
    s_nop 7
    s_sub_u32 s69, s69, 1
    s_cbranch_scc1 L_retry_26_to
    buffer_load_dwordx4 v[240:243], v5, s[8:11], s47 offen offset:0 sc1
    buffer_load_dwordx4 v[244:247], v5, s[8:11], s47 offen offset:1024 sc1
    buffer_load_dwordx4 v[248:251], v5, s[8:11], s47 offen offset:2048 sc1
    buffer_load_dwordx4 v[252:255], v5, s[8:11], s47 offen offset:3072 sc1
    s_waitcnt vmcnt(0)
    v_max3_u32 v40, v240, v241, v242
    v_max3_u32 v40, v40, v243, v244
    v_max3_u32 v40, v40, v245, v246
    v_max3_u32 v40, v40, v247, v248
    v_max3_u32 v40, v40, v249, v250
    v_max3_u32 v40, v40, v251, v252
    v_max3_u32 v40, v40, v253, v254
    v_max3_u32 v40, v40, v255, v255
    v_cmp_eq_u32 vcc, -1, v40
    s_cbranch_vccnz L_retry_26
    s_nop 7
    s_branch L_cont_27
L_retry_26_to:
    s_mov_b32 s69, 0
    s_nop 7
    s_branch L_cont_27
L_retry_28:
    s_nop 7
    s_nop 7
    s_sub_u32 s69, s69, 1
    s_cbranch_scc1 L_retry_28_to
    s_add_u32 s70, s40, 0
    buffer_load_dwordx4 v[128:131], v5, s[8:11], s70 offen sc1
    s_add_u32 s70, s44, 0
    buffer_load_dwordx4 v[132:135], v5, s[8:11], s70 offen sc1
    s_add_u32 s70, s41, 0
    buffer_load_dwordx4 v[136:139], v5, s[8:11], s70 offen sc1
    s_add_u32 s70, s45, 0
    buffer_load_dwordx4 v[140:143], v5, s[8:11], s70 offen sc1
    s_waitcnt vmcnt(0)
    v_max3_u32 v12, v128, v129, v130
    v_max3_u32 v12, v12, v131, v132
    v_max3_u32 v12, v12, v133, v134
    v_max3_u32 v12, v12, v135, v136
    v_max3_u32 v12, v12, v137, v138
    v_max3_u32 v12, v12, v139, v140
    v_max3_u32 v12, v12, v141, v142
    v_max3_u32 v12, v12, v143, v143
    v_cmp_eq_u32 vcc, -1, v12
    s_cbranch_vccnz L_retry_28
    s_nop 7
    s_branch L_cont_29
L_retry_28_to:
    s_mov_b32 s69, 0
    s_nop 7
    s_branch L_cont_29
L_retry_30:
    s_nop 7
    s_nop 7
    s_sub_u32 s69, s69, 1
    s_cbranch_scc1 L_retry_30_to
    s_add_u32 s70, s42, 0
    buffer_load_dwordx4 v[144:147], v5, s[8:11], s70 offen sc1
    s_add_u32 s70, s46, 0
    buffer_load_dwordx4 v[148:151], v5, s[8:11], s70 offen sc1
    s_add_u32 s70, s43, 0
    buffer_load_dwordx4 v[152:155], v5, s[8:11], s70 offen sc1
    s_add_u32 s70, s47, 0
    buffer_load_dwordx4 v[156:159], v5, s[8:11], s70 offen sc1
    s_waitcnt vmcnt(0)
    v_max3_u32 v12, v144, v145, v146
    v_max3_u32 v12, v12, v147, v148
    v_max3_u32 v12, v12, v149, v150
    v_max3_u32 v12, v12, v151, v152
    v_max3_u32 v12, v12, v153, v154
    v_max3_u32 v12, v12, v155, v156
    v_max3_u32 v12, v12, v157, v158
    v_max3_u32 v12, v12, v159, v159
    v_cmp_eq_u32 vcc, -1, v12
    s_cbranch_vccnz L_retry_30
    s_nop 7
    s_branch L_cont_31
L_retry_30_to:
    s_mov_b32 s69, 0
    s_nop 7
    s_branch L_cont_31
L_retry_32:
    s_nop 7
    s_nop 7
    s_sub_u32 s69, s69, 1
    s_cbranch_scc1 L_retry_32_to
    s_add_u32 s70, s40, 1024
    buffer_load_dwordx4 v[160:163], v5, s[8:11], s70 offen sc1
    s_add_u32 s70, s44, 1024
    buffer_load_dwordx4 v[164:167], v5, s[8:11], s70 offen sc1
    s_add_u32 s70, s41, 1024
    buffer_load_dwordx4 v[168:171], v5, s[8:11], s70 offen sc1
    s_add_u32 s70, s45, 1024
    buffer_load_dwordx4 v[172:175], v5, s[8:11], s70 offen sc1
    s_waitcnt vmcnt(0)
    v_max3_u32 v12, v160, v161, v162
    v_max3_u32 v12, v12, v163, v164
    v_max3_u32 v12, v12, v165, v166
    v_max3_u32 v12, v12, v167, v168
    v_max3_u32 v12, v12, v169, v170
    v_max3_u32 v12, v12, v171, v172
    v_max3_u32 v12, v12, v173, v174
    v_max3_u32 v12, v12, v175, v175
    v_cmp_eq_u32 vcc, -1, v12
    s_cbranch_vccnz L_retry_32
    s_nop 7
    s_branch L_cont_33
L_retry_32_to:
    s_mov_b32 s69, 0
    s_nop 7
    s_branch L_cont_33
L_retry_34:
    s_nop 7
    s_nop 7
    s_sub_u32 s69, s69, 1
    s_cbranch_scc1 L_retry_34_to
    s_add_u32 s70, s42, 1024
    buffer_load_dwordx4 v[176:179], v5, s[8:11], s70 offen sc1
    s_add_u32 s70, s46, 1024
    buffer_load_dwordx4 v[180:183], v5, s[8:11], s70 offen sc1
    s_add_u32 s70, s43, 1024
    buffer_load_dwordx4 v[184:187], v5, s[8:11], s70 offen sc1
    s_add_u32 s70, s47, 1024
    buffer_load_dwordx4 v[188:191], v5, s[8:11], s70 offen sc1
    s_waitcnt vmcnt(0)
    v_max3_u32 v12, v176, v177, v178
    v_max3_u32 v12, v12, v179, v180
    v_max3_u32 v12, v12, v181, v182
    v_max3_u32 v12, v12, v183, v184
    v_max3_u32 v12, v12, v185, v186
    v_max3_u32 v12, v12, v187, v188
    v_max3_u32 v12, v12, v189, v190
    v_max3_u32 v12, v12, v191, v191
    v_cmp_eq_u32 vcc, -1, v12
    s_cbranch_vccnz L_retry_34
    s_nop 7
    s_branch L_cont_35
L_retry_34_to:
    s_mov_b32 s69, 0
    s_nop 7
    s_branch L_cont_35
L_retry_36:
    s_nop 7
    s_nop 7
    s_sub_u32 s69, s69, 1
    s_cbranch_scc1 L_retry_36_to
    s_add_u32 s70, s40, 2048
    buffer_load_dwordx4 v[192:195], v5, s[8:11], s70 offen sc1
    s_add_u32 s70, s44, 2048
    buffer_load_dwordx4 v[196:199], v5, s[8:11], s70 offen sc1
    s_add_u32 s70, s41, 2048
    buffer_load_dwordx4 v[200:203], v5, s[8:11], s70 offen sc1
    s_add_u32 s70, s45, 2048
    buffer_load_dwordx4 v[204:207], v5, s[8:11], s70 offen sc1
    s_waitcnt vmcnt(0)
    v_max3_u32 v12, v192, v193, v194
    v_max3_u32 v12, v12, v195, v196
    v_max3_u32 v12, v12, v197, v198
    v_max3_u32 v12, v12, v199, v200
    v_max3_u32 v12, v12, v201, v202
    v_max3_u32 v12, v12, v203, v204
    v_max3_u32 v12, v12, v205, v206
    v_max3_u32 v12, v12, v207, v207
    v_cmp_eq_u32 vcc, -1, v12
    s_cbranch_vccnz L_retry_36
    s_nop 7
    s_branch L_cont_37
L_retry_36_to:
    s_mov_b32 s69, 0
    s_nop 7
    s_branch L_cont_37
L_retry_38:
    s_nop 7
    s_nop 7
    s_sub_u32 s69, s69, 1
    s_cbranch_scc1 L_retry_38_to
    s_add_u32 s70, s42, 2048
    buffer_load_dwordx4 v[208:211], v5, s[8:11], s70 offen sc1
    s_add_u32 s70, s46, 2048
    buffer_load_dwordx4 v[212:215], v5, s[8:11], s70 offen sc1
    s_add_u32 s70, s43, 2048
    buffer_load_dwordx4 v[216:219], v5, s[8:11], s70 offen sc1
    s_add_u32 s70, s47, 2048
    buffer_load_dwordx4 v[220:223], v5, s[8:11], s70 offen sc1
    s_waitcnt vmcnt(0)
    v_max3_u32 v12, v208, v209, v210
    v_max3_u32 v12, v12, v211, v212
    v_max3_u32 v12, v12, v213, v214
    v_max3_u32 v12, v12, v215, v216
    v_max3_u32 v12, v12, v217, v218
    v_max3_u32 v12, v12, v219, v220
    v_max3_u32 v12, v12, v221, v222
    v_max3_u32 v12, v12, v223, v223
    v_cmp_eq_u32 vcc, -1, v12
    s_cbranch_vccnz L_retry_38
    s_nop 7
    s_branch L_cont_39
L_retry_38_to:
    s_mov_b32 s69, 0
    s_nop 7
    s_branch L_cont_39
L_retry_40:
    s_nop 7
    s_nop 7
    s_sub_u32 s69, s69, 1
    s_cbranch_scc1 L_retry_40_to
    s_add_u32 s70, s40, 3072
    buffer_load_dwordx4 v[128:131], v5, s[8:11], s70 offen sc1
    s_add_u32 s70, s44, 3072
    buffer_load_dwordx4 v[132:135], v5, s[8:11], s70 offen sc1
    s_add_u32 s70, s41, 3072
    buffer_load_dwordx4 v[136:139], v5, s[8:11], s70 offen sc1
    s_add_u32 s70, s45, 3072
    buffer_load_dwordx4 v[140:143], v5, s[8:11], s70 offen sc1
    s_waitcnt vmcnt(0)
    v_max3_u32 v12, v128, v129, v130
    v_max3_u32 v12, v12, v131, v132
    v_max3_u32 v12, v12, v133, v134
    v_max3_u32 v12, v12, v135, v136
    v_max3_u32 v12, v12, v137, v138
    v_max3_u32 v12, v12, v139, v140
    v_max3_u32 v12, v12, v141, v142
    v_max3_u32 v12, v12, v143, v143
    v_cmp_eq_u32 vcc, -1, v12
    s_cbranch_vccnz L_retry_40
    s_nop 7
    s_branch L_cont_41
L_retry_40_to:
    s_mov_b32 s69, 0
    s_nop 7
    s_branch L_cont_41
L_retry_42:
    s_nop 7
    s_nop 7
    s_sub_u32 s69, s69, 1
    s_cbranch_scc1 L_retry_42_to
    s_add_u32 s70, s42, 3072
    buffer_load_dwordx4 v[144:147], v5, s[8:11], s70 offen sc1
    s_add_u32 s70, s46, 3072
    buffer_load_dwordx4 v[148:151], v5, s[8:11], s70 offen sc1
    s_add_u32 s70, s43, 3072
    buffer_load_dwordx4 v[152:155], v5, s[8:11], s70 offen sc1
    s_add_u32 s70, s47, 3072
    buffer_load_dwordx4 v[156:159], v5, s[8:11], s70 offen sc1
    s_waitcnt vmcnt(0)
    v_max3_u32 v12, v144, v145, v146
    v_max3_u32 v12, v12, v147, v148
    v_max3_u32 v12, v12, v149, v150
    v_max3_u32 v12, v12, v151, v152
    v_max3_u32 v12, v12, v153, v154
    v_max3_u32 v12, v12, v155, v156
    v_max3_u32 v12, v12, v157, v158
    v_max3_u32 v12, v12, v159, v159
    v_cmp_eq_u32 vcc, -1, v12
    s_cbranch_vccnz L_retry_42
    s_nop 7
    s_branch L_cont_43
L_retry_42_to:
    s_mov_b32 s69, 0
    s_nop 7
    s_branch L_cont_43
L_retry_44:
    s_nop 7
    s_nop 7
    s_sub_u32 s69, s69, 1
    s_cbranch_scc1 L_retry_44_to
    s_add_u32 s70, s40, 4096
    buffer_load_dwordx4 v[160:163], v5, s[8:11], s70 offen sc1
    s_add_u32 s70, s41, 4096
    buffer_load_dwordx4 v[164:167], v5, s[8:11], s70 offen sc1
    s_add_u32 s70, s42, 4096
    buffer_load_dwordx4 v[168:171], v5, s[8:11], s70 offen sc1
    s_add_u32 s70, s43, 4096
    buffer_load_dwordx4 v[172:175], v5, s[8:11], s70 offen sc1
    s_waitcnt vmcnt(0)
    v_max3_u32 v12, v160, v161, v162
    v_max3_u32 v12, v12, v163, v164
    v_max3_u32 v12, v12, v165, v166
    v_max3_u32 v12, v12, v167, v168
    v_max3_u32 v12, v12, v169, v170
    v_max3_u32 v12, v12, v171, v172
    v_max3_u32 v12, v12, v173, v174
    v_max3_u32 v12, v12, v175, v175
    v_cmp_eq_u32 vcc, -1, v12
    s_cbranch_vccnz L_retry_44
    s_nop 7
    s_branch L_cont_45
L_retry_44_to:
    s_mov_b32 s69, 0
    s_nop 7
    s_branch L_cont_45
L_retry_46:
    s_nop 7
    s_nop 7
    s_sub_u32 s69, s69, 1
    s_cbranch_scc1 L_retry_46_to
    s_add_u32 s70, s40, 5120
    buffer_load_dwordx4 v[176:179], v5, s[8:11], s70 offen sc1
    s_add_u32 s70, s41, 5120
    buffer_load_dwordx4 v[180:183], v5, s[8:11], s70 offen sc1
    s_add_u32 s70, s42, 5120
    buffer_load_dwordx4 v[184:187], v5, s[8:11], s70 offen sc1
    s_add_u32 s70, s43, 5120
    buffer_load_dwordx4 v[188:191], v5, s[8:11], s70 offen sc1
    s_waitcnt vmcnt(0)
    v_max3_u32 v12, v176, v177, v178
    v_max3_u32 v12, v12, v179, v180
    v_max3_u32 v12, v12, v181, v182
    v_max3_u32 v12, v12, v183, v184
    v_max3_u32 v12, v12, v185, v186
    v_max3_u32 v12, v12, v187, v188
    v_max3_u32 v12, v12, v189, v190
    v_max3_u32 v12, v12, v191, v191
    v_cmp_eq_u32 vcc, -1, v12
    s_cbranch_vccnz L_retry_46
    s_nop 7
    s_branch L_cont_47
L_retry_46_to:
    s_mov_b32 s69, 0
    s_nop 7
    s_branch L_cont_47
L_retry_48:
    s_nop 7
    s_nop 7
    s_sub_u32 s69, s69, 1
    s_cbranch_scc1 L_retry_48_to
    s_add_u32 s70, s40, 6144
    buffer_load_dwordx4 v[192:195], v5, s[8:11], s70 offen sc1
    s_add_u32 s70, s41, 6144
    buffer_load_dwordx4 v[196:199], v5, s[8:11], s70 offen sc1
    s_add_u32 s70, s42, 6144
    buffer_load_dwordx4 v[200:203], v5, s[8:11], s70 offen sc1
    s_add_u32 s70, s43, 6144
    buffer_load_dwordx4 v[204:207], v5, s[8:11], s70 offen sc1
    s_waitcnt vmcnt(0)
    v_max3_u32 v12, v192, v193, v194
    v_max3_u32 v12, v12, v195, v196
    v_max3_u32 v12, v12, v197, v198
    v_max3_u32 v12, v12, v199, v200
    v_max3_u32 v12, v12, v201, v202
    v_max3_u32 v12, v12, v203, v204
    v_max3_u32 v12, v12, v205, v206
    v_max3_u32 v12, v12, v207, v207
    v_cmp_eq_u32 vcc, -1, v12
    s_cbranch_vccnz L_retry_48
    s_nop 7
    s_branch L_cont_49
L_retry_48_to:
    s_mov_b32 s69, 0
    s_nop 7
    s_branch L_cont_49
L_retry_50:
    s_nop 7
    s_nop 7
    s_sub_u32 s69, s69, 1
    s_cbranch_scc1 L_retry_50_to
    s_add_u32 s70, s44, 4096
    buffer_load_dwordx4 v[208:211], v5, s[8:11], s70 offen sc1
    s_add_u32 s70, s45, 4096
    buffer_load_dwordx4 v[212:215], v5, s[8:11], s70 offen sc1
    s_add_u32 s70, s46, 4096
    buffer_load_dwordx4 v[216:219], v5, s[8:11], s70 offen sc1
    s_add_u32 s70, s47, 4096
    buffer_load_dwordx4 v[220:223], v5, s[8:11], s70 offen sc1
    s_waitcnt vmcnt(0)
    v_max3_u32 v12, v208, v209, v210
    v_max3_u32 v12, v12, v211, v212
    v_max3_u32 v12, v12, v213, v214
    v_max3_u32 v12, v12, v215, v216
    v_max3_u32 v12, v12, v217, v218
    v_max3_u32 v12, v12, v219, v220
    v_max3_u32 v12, v12, v221, v222
    v_max3_u32 v12, v12, v223, v223
    v_cmp_eq_u32 vcc, -1, v12
    s_cbranch_vccnz L_retry_50
    s_nop 7
    s_branch L_cont_51
L_retry_50_to:
    s_mov_b32 s69, 0
    s_nop 7
    s_branch L_cont_51
L_retry_52:
    s_nop 7
    s_nop 7
    s_sub_u32 s69, s69, 1
    s_cbranch_scc1 L_retry_52_to
    s_add_u32 s70, s44, 5120
    buffer_load_dwordx4 v[128:131], v5, s[8:11], s70 offen sc1
    s_add_u32 s70, s45, 5120
    buffer_load_dwordx4 v[132:135], v5, s[8:11], s70 offen sc1
    s_add_u32 s70, s46, 5120
    buffer_load_dwordx4 v[136:139], v5, s[8:11], s70 offen sc1
    s_add_u32 s70, s47, 5120
    buffer_load_dwordx4 v[140:143], v5, s[8:11], s70 offen sc1
    s_waitcnt vmcnt(0)
    v_max3_u32 v12, v128, v129, v130
    v_max3_u32 v12, v12, v131, v132
    v_max3_u32 v12, v12, v133, v134
    v_max3_u32 v12, v12, v135, v136
    v_max3_u32 v12, v12, v137, v138
    v_max3_u32 v12, v12, v139, v140
    v_max3_u32 v12, v12, v141, v142
    v_max3_u32 v12, v12, v143, v143
    v_cmp_eq_u32 vcc, -1, v12
    s_cbranch_vccnz L_retry_52
    s_nop 7
    s_branch L_cont_53
L_retry_52_to:
    s_mov_b32 s69, 0
    s_nop 7
    s_branch L_cont_53
L_retry_54:
    s_nop 7
    s_nop 7
    s_sub_u32 s69, s69, 1
    s_cbranch_scc1 L_retry_54_to
    s_add_u32 s70, s44, 6144
    buffer_load_dwordx4 v[144:147], v5, s[8:11], s70 offen sc1
    s_add_u32 s70, s45, 6144
    buffer_load_dwordx4 v[148:151], v5, s[8:11], s70 offen sc1
    s_add_u32 s70, s46, 6144
    buffer_load_dwordx4 v[152:155], v5, s[8:11], s70 offen sc1
    s_add_u32 s70, s47, 6144
    buffer_load_dwordx4 v[156:159], v5, s[8:11], s70 offen sc1
    s_waitcnt vmcnt(0)
    v_max3_u32 v12, v144, v145, v146
    v_max3_u32 v12, v12, v147, v148
    v_max3_u32 v12, v12, v149, v150
    v_max3_u32 v12, v12, v151, v152
    v_max3_u32 v12, v12, v153, v154
    v_max3_u32 v12, v12, v155, v156
    v_max3_u32 v12, v12, v157, v158
    v_max3_u32 v12, v12, v159, v159
    v_cmp_eq_u32 vcc, -1, v12
    s_cbranch_vccnz L_retry_54
    s_nop 7
    s_branch L_cont_55
L_retry_54_to:
    s_mov_b32 s69, 0
    s_nop 7
    s_branch L_cont_55
L_code_end:
.section .rodata,"a"
.p2align 6
.amdhsa_kernel sequential_preLN__spectral_gfnet__mixer_channel_mlp__prompt_kernel
  .amdhsa_next_free_vgpr 512
  .amdhsa_next_free_sgpr 102
  .amdhsa_accum_offset 256
  .amdhsa_group_segment_fixed_size 0
  .amdhsa_kernarg_size 88
  .amdhsa_user_sgpr_count 2
  .amdhsa_user_sgpr_kernarg_segment_ptr 1
  .amdhsa_system_sgpr_workgroup_id_x 1
  .amdhsa_float_denorm_mode_32 3
.end_amdhsa_kernel
```
